```python
import torch

def _softmax(x, axis=-1):
    return torch.softmax(x, dim=axis)
def _gelu(x):
    return torch.nn.functional.gelu(x, approximate="tanh")
def _silu(x):
    return torch.nn.functional.silu(x)
def _sigmoid(x):
    return torch.sigmoid(x)
def _layernorm(x, axis=-1, eps=1e-5):
    m = x.mean(dim=axis, keepdim=True)
    v = x.var(dim=axis, keepdim=True, unbiased=False)
    return (x - m) / torch.sqrt(v + eps)
def _scatter_add(tgt, idx, src, axis=0):
    return tgt.clone().index_add_(axis, idx, src)
def _segment_sum(src, seg, n):
    out = torch.zeros((n,) + src.shape[1:], dtype=src.dtype)
    return out.index_add_(0, seg, src)
def _pad(x, pw):
    flat = tuple(v for pair in reversed(pw) for v in pair)
    return torch.nn.functional.pad(x, flat)

kernel_name = 'standalone__weight_only_int_gptq__prompt'

def setup_inputs():

    _w = (lambda a: (lambda t: t.to(torch.bfloat16) if t.is_floating_point() else t)(torch.as_tensor(a)))
    B, S, D, F = 1, 2048, 1024, 3584
    bits = max(2, min(4, 2))
    pf = 32 // bits
    G = 64 if 64 > 0 else D
    G = max(pf, (G // pf) * pf)
    D = max(G, (D // G) * G)
    ng = D // G
    qmax = 1 << bits
    qw = torch.randint(0, qmax, (D, F)).to(torch.int64)
    packed = torch.zeros((D // pf, F), dtype=torch.int64)
    for i in range(pf):
        packed |= (qw[i::pf] << (i * bits))
    packed = packed.to(torch.int32)
    return {
        "x": _w((lambda *s: torch.randn(*s, dtype=torch.bfloat16) * 0.05)(B, S, D)),
        "qw_packed": _w(packed),
        "scales": _w(torch.abs((lambda *s: torch.randn(*s, dtype=torch.bfloat16) * 0.05)(ng, F)).to(float) * 0.1 + 0.01),
        "zeros": _w(torch.randint(0, qmax, (ng, F)).to(float)),
        "bits": _w((lambda _x: torch.as_tensor(_x, dtype=torch.int32))(bits)),
    }

def reference(x, qw_packed, scales, zeros, bits):
    b = int(bits)
    pf = 32 // b
    mask = (1 << b) - 1
    P, F = qw_packed.shape
    D = P * pf
    ng = scales.shape[0]
    G = D // ng
    shifts = (lambda x, dt: x.to(dt))(torch.arange(pf) * b, qw_packed.dtype)
    qw = ((qw_packed[:, None, :] >> shifts[None, :, None]) & mask).reshape(D, F)
    s = (lambda x, n, axis: torch.repeat_interleave(x, n, dim=axis))(scales, G, axis=0)
    z = (lambda x, n, axis: torch.repeat_interleave(x, n, dim=axis))(zeros, G, axis=0)
    w = ((lambda x, dt: x.to(dt))(qw, x.dtype) - z) * s
    return torch.einsum("bsd,df->bsf", x, w)
```

```asm
; @launch grid=(252,1,1) block=(256,1,1) lds=163840
.amdgcn_target "amdgcn-amd-amdhsa--gfx950"
.text
.globl standalone__weight_only_int_gptq__prompt_kernel
.p2align 12
.p2align 8
.type standalone__weight_only_int_gptq__prompt_kernel,@function
standalone__weight_only_int_gptq__prompt_kernel:
    s_load_dwordx8 s[8:15], s[0:1], 0
    v_readfirstlane_b32 s44, v0
    s_cmp_ge_u32 s2, 252
    s_cbranch_scc1 L_exit
    s_getpc_b64 s[4:5]
L_pc:
    s_and_b32 s3, s2, 0x38
    s_lshl_b32 s3, s3, 4
    v_lshl_add_u32 v24, v0, 10, s3
    v_cmp_gt_u32 vcc, L_end-L_pc, v24
    s_and_saveexec_b64 s[6:7], vcc
    s_cbranch_execz L_nopf
    global_load_dword v24, v24, s[4:5]
L_nopf:
    s_mov_b64 exec, s[6:7]
    s_and_b32 s50, s2, 7
    s_lshr_b32 s51, s2, 3
    s_sub_u32 s3, s2, 224
    s_cmp_ge_u32 s2, 224
    s_cselect_b32 s50, 8, s50
    s_cselect_b32 s51, s3, s51
    s_mov_b32 s52, s51
    s_lshr_b32 s3, s44, 6
    s_lshl2_add_u32 s52, s52, s3
    v_and_b32 v80, 15, v0
    s_lshl_b32 s3, s51, 8
    v_bfe_u32 v82, v0, 5, 1
    s_mov_b32 s26, 114688
    v_bfe_u32 v83, v0, 4, 1
    s_mov_b32 s27, 0x20000
    v_bfe_u32 v81, v0, 4, 2
    s_add_u32 s64, s3, s44
    v_lshl_add_u32 v18, v83, 1, v82
    s_mov_b64 s[30:31], s[26:27]
    v_mul_u32_u24 v16, 28672, v81
    s_lshl_b32 s56, s64, 1
    v_mul_u32_u24 v18, 7168, v18
    s_mul_i32 s46, s50, 491520
    v_lshl_add_u32 v16, v80, 3, v16
    s_mov_b32 s22, 917504
    v_lshl_add_u32 v18, v80, 2, v18
    s_mul_i32 s52, s52, 9
    v_mad_u32_u24 v34, v82, 6, v83
    s_and_b32 s3, s44, 64
    v_bfe_u32 v1, v0, 3, 3
    s_mov_b32 s23, s27
    v_bitop3_b32 v34, v34, v0, 7 bitop3:0x28
    s_lshl_b32 s3, s3, 8
    v_add_u32 v17, 14336, v16
    s_and_b32 s49, s44, 128
    v_lshl_add_u32 v1, v1, 7, v34
    s_add_u32 s48, s46, s3
    v_and_b32 v35, 63, v0
    s_lshl_b32 s45, s44, 4
    v_min_u32 v35, 8, v35
    s_add_u32 s48, s48, s49
    v_add_u32 v35, s52, v35
    s_mov_b32 s18, 4194304
    v_min_u32 v35, 959, v35
    s_mov_b32 s19, s27
    v_mul_u32_u24 v36, 16384, v35
    s_mov_b32 m0, s45
    v_lshrrev_b32 v36, 16, v36
    s_add_u32 s57, s56, 114688
    v_mul_u32_u24 v36, 12, v36
    s_add_u32 s65, s64, 28672
    v_add_lshl_u32 v25, v35, v36, 7
    s_mul_i32 s47, s50, 1720320
    v_lshl_add_u32 v1, v1, 4, s48
    s_add_u32 s47, s47, s64
    v_add_u32 v25, s46, v25
    s_mov_b32 s36, 0x04040000
    v_add_u32 v2, 32768, v1
    s_mov_b32 s37, 0x05050101
    v_add_u32 v3, 65536, v1
    s_mov_b32 s38, 0x06060202
    v_add_u32 v4, 98304, v1
    s_mov_b32 s39, 0x07070303
    v_add_u32 v5, 131072, v1
    s_mov_b32 s40, 0x03030303
    v_add_u32 v6, 163840, v1
    s_mov_b32 s41, 0x40400000
    v_add_u32 v7, 196608, v1
    s_mov_b32 s42, 0x06040200
    v_add_u32 v8, 229376, v1
    s_mov_b32 s43, 0x07050301
    v_mov_b32 v19, 0x04000400
    v_bfe_u32 v30, v0, 2, 1
    v_bfe_u32 v31, v0, 1, 1
    v_lshl_add_u32 v32, v82, 4, v80
    v_mad_u32_u24 v30, v30, 6, v31
    v_lshlrev_b32 v31, 2, v83
    v_lshlrev_b32 v32, 7, v32
    v_xor_b32 v30, v30, v31
    v_mul_u32_u24 v20, 28672, v81
    v_lshl_add_u32 v26, v30, 4, v32
    v_lshl_add_u32 v20, v80, 2, v20
    v_xor_b32 v27, 16, v26
    s_mov_b32 s34, 14680064
    v_xor_b32 v28, 32, v26
    s_mov_b32 s35, s27
    v_xor_b32 v29, 48, v26
    s_add_u32 s58, s56, 229376
    v_add_u32 v9, 262144, v1
    s_add_u32 s59, s56, 344064
    v_add_u32 v10, 294912, v1
    s_add_u32 s60, s56, 458752
    v_add_u32 v11, 327680, v1
    s_add_u32 s61, s56, 573440
    v_add_u32 v12, 360448, v1
    s_add_u32 s62, s56, 688128
    v_add_u32 v13, 393216, v1
    s_add_u32 s63, s56, 802816
    v_add_u32 v14, 425984, v1
    s_add_u32 s66, s64, 57344
    v_add_u32 v15, 458752, v1
    s_add_u32 s67, s64, 86016
    v_add_u32 v21, 7168, v20
    v_add_u32 v22, 14336, v20
    v_add_u32 v23, 21504, v20
    v_add_u32 v30, 0x10000, v26
    v_add_u32 v31, 0x10000, v27
    v_add_u32 v32, 0x10000, v28
    v_add_u32 v33, 0x10000, v29
    v_add_u32 v34, 0x20000, v26
    v_add_u32 v35, 0x20000, v27
    v_add_u32 v36, 0x20000, v28
    v_add_u32 v37, 0x20000, v29
    s_waitcnt lgkmcnt(0)
    s_mov_b64 s[24:25], s[12:13]
    buffer_load_dword v50, v18, s[24:27], s64 offen
    s_mov_b64 s[28:29], s[14:15]
    buffer_load_dword v51, v18, s[28:31], s64 offen
    s_mov_b64 s[20:21], s[10:11]
    buffer_load_dwordx2 v[38:39], v16, s[20:23], s56 offen
    buffer_load_dwordx2 v[40:41], v17, s[20:23], s56 offen
    s_barrier
    s_mov_b64 s[16:17], s[8:9]
    buffer_load_dwordx4 v1, s[16:19], 0 offen offset:0 lds
    s_add_u32 m0, s45, 4096
    s_nop 0
    buffer_load_dwordx4 v2, s[16:19], 0 offen offset:0 lds
    s_add_u32 m0, s45, 8192
    s_nop 0
    buffer_load_dwordx4 v3, s[16:19], 0 offen offset:0 lds
    s_add_u32 m0, s45, 12288
    s_nop 0
    buffer_load_dwordx4 v4, s[16:19], 0 offen offset:0 lds
    s_barrier
    buffer_load_dword v24, v25, s[16:19], 0 offen offset:0
    buffer_load_dwordx2 v[42:43], v16, s[20:23], s57 offen
    buffer_load_dwordx2 v[44:45], v17, s[20:23], s57 offen
    s_load_dwordx2 s[32:33], s[0:1], 40
    s_add_u32 s68, s20, s58
    s_addc_u32 s69, s21, 0
    s_add_u32 s70, s20, s59
    s_addc_u32 s71, s21, 0
    s_add_u32 s72, s20, s60
    s_addc_u32 s73, s21, 0
    s_add_u32 s74, s20, s61
    s_addc_u32 s75, s21, 0
    s_add_u32 s76, s20, s62
    s_addc_u32 s77, s21, 0
    s_add_u32 s78, s20, s63
    s_addc_u32 s79, s21, 0
    s_add_u32 s80, s24, s65
    s_addc_u32 s81, s25, 0
    s_add_u32 s82, s28, s65
    s_addc_u32 s83, s29, 0
    s_add_u32 s84, s24, s66
    s_addc_u32 s85, s25, 0
    s_add_u32 s86, s28, s66
    s_addc_u32 s87, s29, 0
    s_add_u32 s88, s24, s67
    s_addc_u32 s89, s25, 0
    s_add_u32 s90, s28, s67
    s_addc_u32 s91, s29, 0
    s_waitcnt lgkmcnt(0)
    s_cmp_ge_u32 s2, 224
    s_cbranch_scc1 L_B
    s_mov_b64 vcc, -1
    s_cmp_eq_u32 s44, 0
    s_cbranch_scc1 L_padA0
    s_cmp_eq_u32 s44, 64
    s_cbranch_scc1 L_padA1
    s_cmp_eq_u32 s44, 128
    s_cbranch_scc1 L_padA2
    s_cmp_eq_u32 s44, 192
    s_cbranch_scc1 L_padA3
L_backA:
    s_mov_b64 vcc, 0
    s_waitcnt vmcnt(9)
    s_add_u32 m0, s45, 16384
    s_nop 0
    buffer_load_dwordx4 v5, s[16:19], 0 offen offset:0 lds
    s_add_u32 m0, s45, 20480
    s_nop 0
    buffer_load_dwordx4 v6, s[16:19], 0 offen offset:0 lds
    s_add_u32 m0, s45, 24576
    s_nop 0
    buffer_load_dwordx4 v7, s[16:19], 0 offen offset:0 lds
    s_add_u32 m0, s45, 28672
    s_nop 0
    buffer_load_dwordx4 v8, s[16:19], 0 offen offset:0 lds
    v_lshlrev_b32 v84, 16, v50
    v_lshlrev_b32 v85, 16, v51
    v_mul_f32 v80, v85, v84
    v_sub_f32 v81, v84, v80
    v_fma_f32 v82, 2.0, v84, -v80
    v_fma_f32 v83, s41, v84, -v80
    v_cvt_pk_bf16_f32 v80, -v80, v81
    v_cvt_pk_bf16_f32 v82, v82, v83
    v_perm_b32 v54, v82, v80, s42
    v_perm_b32 v58, v82, v80, s42
    v_perm_b32 v55, v82, v80, s43
    v_perm_b32 v59, v82, v80, s43
    v_and_b32 v84, 0xffff0000, v50
    v_and_b32 v85, 0xffff0000, v51
    v_mul_f32 v80, v85, v84
    v_sub_f32 v81, v84, v80
    v_fma_f32 v82, 2.0, v84, -v80
    v_fma_f32 v83, s41, v84, -v80
    v_cvt_pk_bf16_f32 v80, -v80, v81
    v_cvt_pk_bf16_f32 v82, v82, v83
    v_perm_b32 v56, v82, v80, s42
    v_perm_b32 v60, v82, v80, s42
    v_perm_b32 v57, v82, v80, s43
    v_perm_b32 v61, v82, v80, s43
    v_permlane16_swap_b32 v54, v58
    v_permlane16_swap_b32 v55, v59
    v_permlane16_swap_b32 v56, v60
    v_permlane16_swap_b32 v57, v61
    s_waitcnt vmcnt(12)
    v_lshrrev_b64 v[70:71], 2, v[38:39]
    v_perm_b32 v72, v70, v38, s36
    v_perm_b32 v73, v70, v38, s37
    v_and_or_b32 v88, v72, s40, v19
    v_lshrrev_b64 v[74:75], 4, v[72:73]
    v_and_or_b32 v90, v73, s40, v19
    v_perm_b32 v88, v55, v54, v88
    v_and_or_b32 v89, v74, s40, v19
    v_perm_b32 v90, v55, v54, v90
    v_and_or_b32 v91, v75, s40, v19
    v_perm_b32 v89, v55, v54, v89
    v_perm_b32 v91, v55, v54, v91
    v_perm_b32 v76, v71, v39, s36
    v_perm_b32 v77, v71, v39, s37
    v_and_or_b32 v92, v76, s40, v19
    v_lshrrev_b64 v[78:79], 4, v[76:77]
    v_and_or_b32 v94, v77, s40, v19
    v_perm_b32 v92, v57, v56, v92
    v_and_or_b32 v93, v78, s40, v19
    v_perm_b32 v94, v57, v56, v94
    v_and_or_b32 v95, v79, s40, v19
    v_perm_b32 v93, v57, v56, v93
    v_perm_b32 v95, v57, v56, v95
    v_perm_b32 v72, v70, v38, s38
    v_perm_b32 v73, v70, v38, s39
    v_and_or_b32 v96, v72, s40, v19
    v_lshrrev_b64 v[74:75], 4, v[72:73]
    v_and_or_b32 v98, v73, s40, v19
    v_perm_b32 v96, v55, v54, v96
    v_and_or_b32 v97, v74, s40, v19
    v_perm_b32 v98, v55, v54, v98
    v_and_or_b32 v99, v75, s40, v19
    v_perm_b32 v97, v55, v54, v97
    v_perm_b32 v99, v55, v54, v99
    v_perm_b32 v76, v71, v39, s38
    v_perm_b32 v77, v71, v39, s39
    v_and_or_b32 v100, v76, s40, v19
    v_lshrrev_b64 v[78:79], 4, v[76:77]
    v_and_or_b32 v102, v77, s40, v19
    v_perm_b32 v100, v57, v56, v100
    v_and_or_b32 v101, v78, s40, v19
    v_perm_b32 v102, v57, v56, v102
    v_and_or_b32 v103, v79, s40, v19
    v_perm_b32 v101, v57, v56, v101
    v_perm_b32 v103, v57, v56, v103
    s_waitcnt vmcnt(11)
    v_lshrrev_b64 v[70:71], 2, v[40:41]
    v_perm_b32 v72, v70, v40, s36
    v_perm_b32 v73, v70, v40, s37
    v_and_or_b32 v104, v72, s40, v19
    v_lshrrev_b64 v[74:75], 4, v[72:73]
    v_and_or_b32 v106, v73, s40, v19
    v_perm_b32 v104, v55, v54, v104
    v_and_or_b32 v105, v74, s40, v19
    v_perm_b32 v106, v55, v54, v106
    v_and_or_b32 v107, v75, s40, v19
    v_perm_b32 v105, v55, v54, v105
    v_perm_b32 v107, v55, v54, v107
    v_perm_b32 v76, v71, v41, s36
    v_perm_b32 v77, v71, v41, s37
    v_and_or_b32 v108, v76, s40, v19
    v_lshrrev_b64 v[78:79], 4, v[76:77]
    v_and_or_b32 v110, v77, s40, v19
    v_perm_b32 v108, v57, v56, v108
    v_and_or_b32 v109, v78, s40, v19
    v_perm_b32 v110, v57, v56, v110
    v_and_or_b32 v111, v79, s40, v19
    v_perm_b32 v109, v57, v56, v109
    v_perm_b32 v111, v57, v56, v111
    v_perm_b32 v72, v70, v40, s38
    v_perm_b32 v73, v70, v40, s39
    v_and_or_b32 v112, v72, s40, v19
    v_lshrrev_b64 v[74:75], 4, v[72:73]
    v_and_or_b32 v114, v73, s40, v19
    v_perm_b32 v112, v55, v54, v112
    v_and_or_b32 v113, v74, s40, v19
    v_perm_b32 v114, v55, v54, v114
    v_and_or_b32 v115, v75, s40, v19
    v_perm_b32 v113, v55, v54, v113
    v_perm_b32 v115, v55, v54, v115
    v_perm_b32 v76, v71, v41, s38
    v_perm_b32 v77, v71, v41, s39
    v_and_or_b32 v116, v76, s40, v19
    v_lshrrev_b64 v[78:79], 4, v[76:77]
    v_and_or_b32 v118, v77, s40, v19
    v_perm_b32 v116, v57, v56, v116
    v_and_or_b32 v117, v78, s40, v19
    v_perm_b32 v118, v57, v56, v118
    v_and_or_b32 v119, v79, s40, v19
    v_perm_b32 v117, v57, v56, v117
    v_perm_b32 v119, v57, v56, v119
    s_add_u32 m0, s45, 32768
    s_nop 0
    buffer_load_dwordx4 v9, s[16:19], 0 offen offset:0 lds
    s_add_u32 m0, s45, 36864
    s_nop 0
    buffer_load_dwordx4 v10, s[16:19], 0 offen offset:0 lds
    s_add_u32 m0, s45, 40960
    s_nop 0
    buffer_load_dwordx4 v11, s[16:19], 0 offen offset:0 lds
    s_add_u32 m0, s45, 45056
    s_nop 0
    buffer_load_dwordx4 v12, s[16:19], 0 offen offset:0 lds
    s_waitcnt vmcnt(11)
    s_barrier
    ds_read_b128 a[120:123], v26 offset:0
    ds_read_b128 a[124:127], v27 offset:0
    ds_read_b128 a[128:131], v28 offset:0
    ds_read_b128 a[132:135], v29 offset:0
    ds_read_b128 a[136:139], v26 offset:4096
    ds_read_b128 a[140:143], v27 offset:4096
    ds_read_b128 a[144:147], v28 offset:4096
    ds_read_b128 a[148:151], v29 offset:4096
    ds_read_b128 a[152:155], v26 offset:8192
    ds_read_b128 a[156:159], v27 offset:8192
    ds_read_b128 a[160:163], v28 offset:8192
    ds_read_b128 a[164:167], v29 offset:8192
    s_waitcnt lgkmcnt(11)
    s_nop 0
.p2align 3
    v_mfma_f32_16x16x32_bf16 a[0:3], a[120:123], v[88:91], 0
    s_waitcnt lgkmcnt(10)
    v_mfma_f32_16x16x32_bf16 a[0:3], a[124:127], v[96:99], a[0:3]
    s_waitcnt lgkmcnt(9)
    s_add_u32 m0, s45, 49152
    ds_read_b128 a[168:171], v26 offset:12288
    v_mfma_f32_16x16x32_bf16 a[0:3], a[128:131], v[104:107], a[0:3]
    s_waitcnt lgkmcnt(9)
    buffer_load_dwordx4 v13, s[16:19], 0 offen offset:0 lds
    v_mfma_f32_16x16x32_bf16 a[0:3], a[132:135], v[112:115], a[0:3]
    s_nop 0
    ds_read_b128 a[172:175], v27 offset:12288
    v_mfma_f32_16x16x32_bf16 a[4:7], a[120:123], v[92:95], 0
    v_mfma_f32_16x16x32_bf16 a[4:7], a[124:127], v[100:103], a[4:7]
    s_add_u32 m0, s45, 53248
    ds_read_b128 a[176:179], v28 offset:12288
    v_mfma_f32_16x16x32_bf16 a[4:7], a[128:131], v[108:111], a[4:7]
    buffer_load_dwordx4 v14, s[16:19], 0 offen offset:0 lds
    v_mfma_f32_16x16x32_bf16 a[4:7], a[132:135], v[116:119], a[4:7]
    s_waitcnt vmcnt(6) lgkmcnt(7)
    ds_read_b128 a[180:183], v29 offset:12288
    v_mfma_f32_16x16x32_bf16 a[8:11], a[136:139], v[88:91], 0
    s_barrier
    v_mfma_f32_16x16x32_bf16 a[8:11], a[140:143], v[96:99], a[8:11]
    s_add_u32 m0, s45, 57344
    ds_read_b128 a[120:123], v26 offset:16384
    v_mfma_f32_16x16x32_bf16 a[8:11], a[144:147], v[104:107], a[8:11]
    buffer_load_dwordx4 v15, s[16:19], 0 offen offset:0 lds
    v_mfma_f32_16x16x32_bf16 a[8:11], a[148:151], v[112:115], a[8:11]
    ds_read_b128 a[124:127], v27 offset:16384
    v_mfma_f32_16x16x32_bf16 a[12:15], a[136:139], v[92:95], 0
    v_mfma_f32_16x16x32_bf16 a[12:15], a[140:143], v[100:103], a[12:15]
    s_add_u32 m0, s45, 61184
    ds_read_b128 a[128:131], v28 offset:16384
    v_mfma_f32_16x16x32_bf16 a[12:15], a[144:147], v[108:111], a[12:15]
    buffer_load_dwordx4 v1, s[16:19], 0 offen offset:256 lds
    v_mfma_f32_16x16x32_bf16 a[12:15], a[148:151], v[116:119], a[12:15]
    s_waitcnt lgkmcnt(7)
    ds_read_b128 a[132:135], v29 offset:16384
    v_mfma_f32_16x16x32_bf16 a[16:19], a[152:155], v[88:91], 0
    s_nop 0
    v_mfma_f32_16x16x32_bf16 a[16:19], a[156:159], v[96:99], a[16:19]
    s_add_u32 m0, s45, 65280
    ds_read_b128 a[136:139], v26 offset:20480
    v_mfma_f32_16x16x32_bf16 a[16:19], a[160:163], v[104:107], a[16:19]
    buffer_load_dwordx4 v2, s[16:19], 0 offen offset:256 lds
    v_lshrrev_b64 v[70:71], 2, v[42:43]
    v_perm_b32 v72, v70, v42, s36
    v_perm_b32 v73, v70, v42, s37
    v_and_or_b32 v120, v72, s40, v19
    v_mfma_f32_16x16x32_bf16 a[16:19], a[164:167], v[112:115], a[16:19]
    ds_read_b128 a[140:143], v27 offset:20480
    v_lshrrev_b64 v[74:75], 4, v[72:73]
    v_mfma_f32_16x16x32_bf16 a[20:23], a[152:155], v[92:95], 0
    v_and_or_b32 v122, v73, s40, v19
    v_perm_b32 v120, v59, v58, v120
    v_mfma_f32_16x16x32_bf16 a[20:23], a[156:159], v[100:103], a[20:23]
    s_add_u32 m0, s45, 69376
    ds_read_b128 a[144:147], v28 offset:20480
    v_and_or_b32 v121, v74, s40, v19
    v_mfma_f32_16x16x32_bf16 a[20:23], a[160:163], v[108:111], a[20:23]
    buffer_load_dwordx4 v3, s[16:19], 0 offen offset:256 lds
    v_perm_b32 v122, v59, v58, v122
    v_mfma_f32_16x16x32_bf16 a[20:23], a[164:167], v[116:119], a[20:23]
    s_waitcnt lgkmcnt(7)
    ds_read_b128 a[148:151], v29 offset:20480
    v_and_or_b32 v123, v75, s40, v19
    v_mfma_f32_16x16x32_bf16 a[24:27], a[168:171], v[88:91], 0
    s_nop 0
    v_perm_b32 v121, v59, v58, v121
    v_perm_b32 v123, v59, v58, v123
    v_mfma_f32_16x16x32_bf16 a[24:27], a[172:175], v[96:99], a[24:27]
    s_add_u32 m0, s45, 73472
    ds_read_b128 a[152:155], v26 offset:24576
    v_perm_b32 v76, v71, v43, s36
    v_mfma_f32_16x16x32_bf16 a[24:27], a[176:179], v[104:107], a[24:27]
    buffer_load_dwordx4 v4, s[16:19], 0 offen offset:256 lds
    v_perm_b32 v77, v71, v43, s37
    v_mfma_f32_16x16x32_bf16 a[24:27], a[180:183], v[112:115], a[24:27]
    ds_read_b128 a[156:159], v27 offset:24576
    v_and_or_b32 v124, v76, s40, v19
    v_mfma_f32_16x16x32_bf16 a[28:31], a[168:171], v[92:95], 0
    v_lshrrev_b64 v[78:79], 4, v[76:77]
    v_and_or_b32 v126, v77, s40, v19
    v_mfma_f32_16x16x32_bf16 a[28:31], a[172:175], v[100:103], a[28:31]
    s_add_u32 m0, s45, 77568
    ds_read_b128 a[160:163], v28 offset:24576
    v_perm_b32 v124, v61, v60, v124
    v_mfma_f32_16x16x32_bf16 a[28:31], a[176:179], v[108:111], a[28:31]
    buffer_load_dwordx4 v5, s[16:19], 0 offen offset:256 lds
    v_and_or_b32 v125, v78, s40, v19
    v_mfma_f32_16x16x32_bf16 a[28:31], a[180:183], v[116:119], a[28:31]
    s_waitcnt lgkmcnt(7)
    ds_read_b128 a[164:167], v29 offset:24576
    v_perm_b32 v126, v61, v60, v126
    v_mfma_f32_16x16x32_bf16 a[32:35], a[120:123], v[88:91], 0
    s_nop 0
    v_and_or_b32 v127, v79, s40, v19
    v_perm_b32 v125, v61, v60, v125
    v_mfma_f32_16x16x32_bf16 a[32:35], a[124:127], v[96:99], a[32:35]
    s_add_u32 m0, s45, 81664
    ds_read_b128 a[168:171], v26 offset:28672
    v_perm_b32 v127, v61, v60, v127
    v_mfma_f32_16x16x32_bf16 a[32:35], a[128:131], v[104:107], a[32:35]
    buffer_load_dwordx4 v6, s[16:19], 0 offen offset:256 lds
    v_perm_b32 v72, v70, v42, s38
    v_mfma_f32_16x16x32_bf16 a[32:35], a[132:135], v[112:115], a[32:35]
    ds_read_b128 a[172:175], v27 offset:28672
    v_perm_b32 v73, v70, v42, s39
    v_mfma_f32_16x16x32_bf16 a[36:39], a[120:123], v[92:95], 0
    v_and_or_b32 v128, v72, s40, v19
    v_lshrrev_b64 v[74:75], 4, v[72:73]
    v_mfma_f32_16x16x32_bf16 a[36:39], a[124:127], v[100:103], a[36:39]
    s_add_u32 m0, s45, 85760
    ds_read_b128 a[176:179], v28 offset:28672
    v_and_or_b32 v130, v73, s40, v19
    v_mfma_f32_16x16x32_bf16 a[36:39], a[128:131], v[108:111], a[36:39]
    buffer_load_dwordx4 v7, s[16:19], 0 offen offset:256 lds
    v_perm_b32 v128, v59, v58, v128
    v_mfma_f32_16x16x32_bf16 a[36:39], a[132:135], v[116:119], a[36:39]
    s_waitcnt vmcnt(10) lgkmcnt(7)
    ds_read_b128 a[180:183], v29 offset:28672
    v_and_or_b32 v129, v74, s40, v19
    v_mfma_f32_16x16x32_bf16 a[40:43], a[136:139], v[88:91], 0
    s_barrier
    v_mfma_f32_16x16x32_bf16 a[40:43], a[140:143], v[96:99], a[40:43]
    s_add_u32 m0, s45, 89856
    ds_read_b128 a[120:123], v26 offset:32768
    v_perm_b32 v130, v59, v58, v130
    v_mfma_f32_16x16x32_bf16 a[40:43], a[144:147], v[104:107], a[40:43]
L_padA0:
    s_cbranch_vccnz L_padA4
    s_nop 0
    buffer_load_dwordx4 v8, s[16:19], 0 offen offset:256 lds
    v_and_or_b32 v131, v75, s40, v19
    v_mfma_f32_16x16x32_bf16 a[40:43], a[148:151], v[112:115], a[40:43]
    s_mov_b64 s[20:21], s[68:69]
    ds_read_b128 a[124:127], v27 offset:32768
    v_perm_b32 v129, v59, v58, v129
    v_mfma_f32_16x16x32_bf16 a[44:47], a[136:139], v[92:95], 0
    s_mov_b64 s[24:25], s[80:81]
    v_perm_b32 v131, v59, v58, v131
    v_perm_b32 v76, v71, v43, s38
    v_mfma_f32_16x16x32_bf16 a[44:47], a[140:143], v[100:103], a[44:47]
    s_add_u32 m0, s45, 93952
    ds_read_b128 a[128:131], v28 offset:32768
    v_perm_b32 v77, v71, v43, s39
    v_mfma_f32_16x16x32_bf16 a[44:47], a[144:147], v[108:111], a[44:47]
    buffer_load_dwordx4 v9, s[16:19], 0 offen offset:256 lds
    v_and_or_b32 v132, v76, s40, v19
    v_mfma_f32_16x16x32_bf16 a[44:47], a[148:151], v[116:119], a[44:47]
    s_waitcnt lgkmcnt(7)
    ds_read_b128 a[132:135], v29 offset:32768
    v_lshrrev_b64 v[78:79], 4, v[76:77]
    v_mfma_f32_16x16x32_bf16 a[48:51], a[152:155], v[88:91], 0
    buffer_load_dword v52, v18, s[24:27], 0 offen
    v_and_or_b32 v134, v77, s40, v19
    v_mfma_f32_16x16x32_bf16 a[48:51], a[156:159], v[96:99], a[48:51]
    s_addk_i32 m0, 4096
    ds_read_b128 a[136:139], v26 offset:36864
    v_perm_b32 v132, v61, v60, v132
    v_mfma_f32_16x16x32_bf16 a[48:51], a[160:163], v[104:107], a[48:51]
    buffer_load_dwordx4 v10, s[16:19], 0 offen offset:256 lds
    v_and_or_b32 v133, v78, s40, v19
    v_mfma_f32_16x16x32_bf16 a[48:51], a[164:167], v[112:115], a[48:51]
    s_mov_b64 s[28:29], s[82:83]
    ds_read_b128 a[140:143], v27 offset:36864
    v_perm_b32 v134, v61, v60, v134
    v_mfma_f32_16x16x32_bf16 a[52:55], a[152:155], v[92:95], 0
    buffer_load_dword v53, v18, s[28:31], 0 offen
    v_and_or_b32 v135, v79, s40, v19
    v_mfma_f32_16x16x32_bf16 a[52:55], a[156:159], v[100:103], a[52:55]
    s_addk_i32 m0, 4096
    ds_read_b128 a[144:147], v28 offset:36864
    v_perm_b32 v133, v61, v60, v133
    v_mfma_f32_16x16x32_bf16 a[52:55], a[160:163], v[108:111], a[52:55]
    buffer_load_dwordx4 v11, s[16:19], 0 offen offset:256 lds
    v_perm_b32 v135, v61, v60, v135
    v_mfma_f32_16x16x32_bf16 a[52:55], a[164:167], v[116:119], a[52:55]
    s_waitcnt lgkmcnt(7)
    ds_read_b128 a[148:151], v29 offset:36864
    v_lshrrev_b64 v[70:71], 2, v[44:45]
    v_mfma_f32_16x16x32_bf16 a[56:59], a[168:171], v[88:91], 0
    buffer_load_dwordx2 v[46:47], v16, s[20:23], 0 offen
    v_perm_b32 v72, v70, v44, s36
    v_mfma_f32_16x16x32_bf16 a[56:59], a[172:175], v[96:99], a[56:59]
    s_addk_i32 m0, 4096
    ds_read_b128 a[152:155], v26 offset:40960
    v_perm_b32 v73, v70, v44, s37
    v_mfma_f32_16x16x32_bf16 a[56:59], a[176:179], v[104:107], a[56:59]
    buffer_load_dwordx4 v12, s[16:19], 0 offen offset:256 lds
    v_and_or_b32 v136, v72, s40, v19
    v_mfma_f32_16x16x32_bf16 a[56:59], a[180:183], v[112:115], a[56:59]
    ds_read_b128 a[156:159], v27 offset:40960
    v_lshrrev_b64 v[74:75], 4, v[72:73]
    v_mfma_f32_16x16x32_bf16 a[60:63], a[168:171], v[92:95], 0
    v_and_or_b32 v138, v73, s40, v19
    v_perm_b32 v136, v59, v58, v136
    v_mfma_f32_16x16x32_bf16 a[60:63], a[172:175], v[100:103], a[60:63]
    s_add_u32 m0, s45, 110336
    ds_read_b128 a[160:163], v28 offset:40960
    v_and_or_b32 v137, v74, s40, v19
    v_mfma_f32_16x16x32_bf16 a[60:63], a[176:179], v[108:111], a[60:63]
    buffer_load_dwordx4 v13, s[16:19], 0 offen offset:256 lds
    v_perm_b32 v138, v59, v58, v138
    v_mfma_f32_16x16x32_bf16 a[60:63], a[180:183], v[116:119], a[60:63]
    s_waitcnt lgkmcnt(7)
    ds_read_b128 a[164:167], v29 offset:40960
    v_and_or_b32 v139, v75, s40, v19
    v_mfma_f32_16x16x32_bf16 a[64:67], a[120:123], v[88:91], 0
    s_nop 0
    v_perm_b32 v137, v59, v58, v137
    v_perm_b32 v139, v59, v58, v139
    v_perm_b32 v76, v71, v45, s36
    v_mfma_f32_16x16x32_bf16 a[64:67], a[124:127], v[96:99], a[64:67]
    s_add_u32 m0, s45, 114432
    ds_read_b128 a[168:171], v26 offset:45056
    v_perm_b32 v77, v71, v45, s37
    v_mfma_f32_16x16x32_bf16 a[64:67], a[128:131], v[104:107], a[64:67]
    buffer_load_dwordx4 v14, s[16:19], 0 offen offset:256 lds
    v_and_or_b32 v140, v76, s40, v19
    v_mfma_f32_16x16x32_bf16 a[64:67], a[132:135], v[112:115], a[64:67]
    ds_read_b128 a[172:175], v27 offset:45056
    v_lshrrev_b64 v[78:79], 4, v[76:77]
    v_mfma_f32_16x16x32_bf16 a[68:71], a[120:123], v[92:95], 0
    v_and_or_b32 v142, v77, s40, v19
    v_perm_b32 v140, v61, v60, v140
    v_mfma_f32_16x16x32_bf16 a[68:71], a[124:127], v[100:103], a[68:71]
    ds_read_b128 a[176:179], v28 offset:45056
    v_and_or_b32 v141, v78, s40, v19
    v_mfma_f32_16x16x32_bf16 a[68:71], a[128:131], v[108:111], a[68:71]
    v_perm_b32 v142, v61, v60, v142
    v_and_or_b32 v143, v79, s40, v19
    v_mfma_f32_16x16x32_bf16 a[68:71], a[132:135], v[116:119], a[68:71]
    s_waitcnt vmcnt(16) lgkmcnt(7)
    ds_read_b128 a[180:183], v29 offset:45056
    v_perm_b32 v141, v61, v60, v141
    v_mfma_f32_16x16x32_bf16 a[72:75], a[136:139], v[88:91], 0
    s_barrier
    v_mfma_f32_16x16x32_bf16 a[72:75], a[140:143], v[96:99], a[72:75]
    s_add_u32 m0, s45, 118528
    ds_read_b128 a[120:123], v26 offset:49152
    v_perm_b32 v143, v61, v60, v143
    v_mfma_f32_16x16x32_bf16 a[72:75], a[144:147], v[104:107], a[72:75]
    buffer_load_dwordx4 v15, s[16:19], 0 offen offset:256 lds
    v_perm_b32 v72, v70, v44, s38
    v_mfma_f32_16x16x32_bf16 a[72:75], a[148:151], v[112:115], a[72:75]
    s_mov_b64 s[24:25], s[84:85]
    ds_read_b128 a[124:127], v27 offset:49152
    v_perm_b32 v73, v70, v44, s39
    v_mfma_f32_16x16x32_bf16 a[76:79], a[136:139], v[92:95], 0
    buffer_load_dword v50, v18, s[24:27], 0 offen
    v_and_or_b32 v144, v72, s40, v19
    v_mfma_f32_16x16x32_bf16 a[76:79], a[140:143], v[100:103], a[76:79]
    s_nop 0
    ds_read_b128 a[128:131], v28 offset:49152
    v_lshrrev_b64 v[74:75], 4, v[72:73]
    v_mfma_f32_16x16x32_bf16 a[76:79], a[144:147], v[108:111], a[76:79]
    s_add_u32 m0, s45, 122368
    v_and_or_b32 v146, v73, s40, v19
    v_perm_b32 v144, v59, v58, v144
    v_mfma_f32_16x16x32_bf16 a[76:79], a[148:151], v[116:119], a[76:79]
    s_waitcnt lgkmcnt(7)
    ds_read_b128 a[132:135], v29 offset:49152
    v_and_or_b32 v145, v74, s40, v19
    v_mfma_f32_16x16x32_bf16 a[80:83], a[152:155], v[88:91], 0
    buffer_load_dwordx4 v1, s[16:19], 0 offen offset:512 lds
    v_perm_b32 v146, v59, v58, v146
    v_mfma_f32_16x16x32_bf16 a[80:83], a[156:159], v[96:99], a[80:83]
    s_mov_b64 s[28:29], s[86:87]
    ds_read_b128 a[136:139], v26 offset:53248
    v_and_or_b32 v147, v75, s40, v19
    v_mfma_f32_16x16x32_bf16 a[80:83], a[160:163], v[104:107], a[80:83]
    buffer_load_dword v51, v18, s[28:31], 0 offen
    v_perm_b32 v145, v59, v58, v145
    v_mfma_f32_16x16x32_bf16 a[80:83], a[164:167], v[112:115], a[80:83]
    ds_read_b128 a[140:143], v27 offset:53248
    v_perm_b32 v147, v59, v58, v147
    v_mfma_f32_16x16x32_bf16 a[84:87], a[152:155], v[92:95], 0
    buffer_load_dwordx2 v[48:49], v17, s[20:23], 0 offen
    v_perm_b32 v76, v71, v45, s38
    v_mfma_f32_16x16x32_bf16 a[84:87], a[156:159], v[100:103], a[84:87]
    ds_read_b128 a[144:147], v28 offset:53248
    v_perm_b32 v77, v71, v45, s39
    v_mfma_f32_16x16x32_bf16 a[84:87], a[160:163], v[108:111], a[84:87]
    s_add_u32 m0, s45, 126464
    v_and_or_b32 v148, v76, s40, v19
    v_lshrrev_b64 v[78:79], 4, v[76:77]
    v_mfma_f32_16x16x32_bf16 a[84:87], a[164:167], v[116:119], a[84:87]
    s_waitcnt lgkmcnt(7)
    ds_read_b128 a[148:151], v29 offset:53248
    v_and_or_b32 v150, v77, s40, v19
    v_mfma_f32_16x16x32_bf16 a[88:91], a[168:171], v[88:91], 0
    buffer_load_dwordx4 v2, s[16:19], 0 offen offset:512 lds
    v_perm_b32 v148, v61, v60, v148
    v_mfma_f32_16x16x32_bf16 a[88:91], a[172:175], v[96:99], a[88:91]
    s_nop 0
    ds_read_b128 a[152:155], v26 offset:57344
    v_and_or_b32 v149, v78, s40, v19
    v_mfma_f32_16x16x32_bf16 a[88:91], a[176:179], v[104:107], a[88:91]
    v_perm_b32 v150, v61, v60, v150
    v_and_or_b32 v151, v79, s40, v19
    v_mfma_f32_16x16x32_bf16 a[88:91], a[180:183], v[112:115], a[88:91]
    ds_read_b128 a[156:159], v27 offset:57344
    v_perm_b32 v149, v61, v60, v149
    v_mfma_f32_16x16x32_bf16 a[92:95], a[168:171], v[92:95], 0
    s_waitcnt vmcnt(11)
    v_perm_b32 v151, v61, v60, v151
    v_lshlrev_b32 v84, 16, v52
    v_mfma_f32_16x16x32_bf16 a[92:95], a[172:175], v[100:103], a[92:95]
    s_add_u32 m0, s45, 130560
    ds_read_b128 a[160:163], v28 offset:57344
    v_lshlrev_b32_e64 v85, 16, v53
    v_mfma_f32_16x16x32_bf16 a[92:95], a[176:179], v[108:111], a[92:95]
    buffer_load_dwordx4 v3, s[16:19], 0 offen offset:512 lds
    v_mul_f32_e64 v80, v85, v84
    v_mfma_f32_16x16x32_bf16 a[92:95], a[180:183], v[116:119], a[92:95]
    s_waitcnt lgkmcnt(7)
    ds_read_b128 a[164:167], v29 offset:57344
    v_sub_f32 v81, v84, v80
    v_mfma_f32_16x16x32_bf16 a[96:99], a[120:123], v[88:91], 0
    v_fma_f32 v82, 2.0, v84, -v80
    v_fma_f32 v83, s41, v84, -v80
    v_mfma_f32_16x16x32_bf16 a[96:99], a[124:127], v[96:99], a[96:99]
    ds_read_b128 a[168:171], v26 offset:61440
    v_cvt_pk_bf16_f32 v80, -v80, v81
    v_mfma_f32_16x16x32_bf16 a[96:99], a[128:131], v[104:107], a[96:99]
    v_cvt_pk_bf16_f32 v82, v82, v83
    v_perm_b32 v62, v82, v80, s42
    v_mfma_f32_16x16x32_bf16 a[96:99], a[132:135], v[112:115], a[96:99]
    ds_read_b128 a[172:175], v27 offset:61440
    v_perm_b32 v66, v82, v80, s42
    v_mfma_f32_16x16x32_bf16 a[100:103], a[120:123], v[92:95], 0
    v_perm_b32 v63, v82, v80, s43
    v_perm_b32 v67, v82, v80, s43
    v_mfma_f32_16x16x32_bf16 a[100:103], a[124:127], v[100:103], a[100:103]
    s_add_u32 m0, s45, 134656
    ds_read_b128 a[176:179], v28 offset:61440
    v_and_b32 v84, 0xffff0000, v52
    v_mfma_f32_16x16x32_bf16 a[100:103], a[128:131], v[108:111], a[100:103]
    buffer_load_dwordx4 v4, s[16:19], 0 offen offset:512 lds
    v_and_b32 v85, 0xffff0000, v53
    v_mfma_f32_16x16x32_bf16 a[100:103], a[132:135], v[116:119], a[100:103]
    s_waitcnt lgkmcnt(7)
    ds_read_b128 a[180:183], v29 offset:61440
    v_mul_f32 v80, v85, v84
    v_mfma_f32_16x16x32_bf16 a[104:107], a[136:139], v[88:91], 0
    s_barrier
    v_mfma_f32_16x16x32_bf16 a[104:107], a[140:143], v[96:99], a[104:107]
    s_nop 0
    ds_read_b128 a[120:123], v30 offset:0
    v_sub_f32_e64 v81, v84, v80
    v_mfma_f32_16x16x32_bf16 a[104:107], a[144:147], v[104:107], a[104:107]
    v_fma_f32 v82, 2.0, v84, -v80
    v_fma_f32 v83, s41, v84, -v80
    v_mfma_f32_16x16x32_bf16 a[104:107], a[148:151], v[112:115], a[104:107]
    s_add_u32 m0, s45, 138752
    ds_read_b128 a[124:127], v31 offset:0
    v_cvt_pk_bf16_f32 v80, -v80, v81
    v_cvt_pk_bf16_f32 v82, v82, v83
    v_mfma_f32_16x16x32_bf16 a[108:111], a[136:139], v[92:95], 0
    buffer_load_dwordx4 v5, s[16:19], 0 offen offset:512 lds
    v_perm_b32 v64, v82, v80, s42
    v_mfma_f32_16x16x32_bf16 a[108:111], a[140:143], v[100:103], a[108:111]
    ds_read_b128 a[128:131], v32 offset:0
    v_perm_b32 v68, v82, v80, s42
    v_mfma_f32_16x16x32_bf16 a[108:111], a[144:147], v[108:111], a[108:111]
    v_perm_b32 v65, v82, v80, s43
    v_perm_b32 v69, v82, v80, s43
    v_mfma_f32_16x16x32_bf16 a[108:111], a[148:151], v[116:119], a[108:111]
    s_waitcnt lgkmcnt(7)
    ds_read_b128 a[132:135], v33 offset:0
    v_mfma_f32_16x16x32_bf16 v[248:251], a[152:155], v[88:91], 0
    s_nop 0
    v_permlane16_swap_b32_e64 v62, v66
    v_mfma_f32_16x16x32_bf16 v[248:251], a[156:159], v[96:99], v[248:251]
    ds_read_b128 a[136:139], v30 offset:4096
    v_permlane16_swap_b32_e64 v63, v67
    v_mfma_f32_16x16x32_bf16 v[248:251], a[160:163], v[104:107], v[248:251]
    v_permlane16_swap_b32_e64 v64, v68
    v_mfma_f32_16x16x32_bf16 v[248:251], a[164:167], v[112:115], v[248:251]
    s_add_u32 m0, s45, 142848
    ds_read_b128 a[140:143], v31 offset:4096
    v_mfma_f32_16x16x32_bf16 v[252:255], a[152:155], v[92:95], 0
    buffer_load_dwordx4 v6, s[16:19], 0 offen offset:512 lds
    v_permlane16_swap_b32_e64 v65, v69
    v_mfma_f32_16x16x32_bf16 v[252:255], a[156:159], v[100:103], v[252:255]
    s_waitcnt vmcnt(13)
    ds_read_b128 a[144:147], v32 offset:4096
    v_lshrrev_b64 v[70:71], 2, v[46:47]
    v_mfma_f32_16x16x32_bf16 v[252:255], a[160:163], v[108:111], v[252:255]
    s_mov_b64 s[20:21], s[70:71]
    v_perm_b32 v72, v70, v46, s36
    v_perm_b32 v73, v70, v46, s37
    v_mfma_f32_16x16x32_bf16 v[252:255], a[164:167], v[116:119], v[252:255]
    s_waitcnt lgkmcnt(7)
    ds_read_b128 a[148:151], v33 offset:4096
    v_and_or_b32 v152, v72, s40, v19
    v_mfma_f32_16x16x32_bf16 a[0:3], a[168:171], v[120:123], a[0:3]
    buffer_load_dwordx2 v[38:39], v16, s[20:23], 0 offen
    v_lshrrev_b64 v[74:75], 4, v[72:73]
    v_mfma_f32_16x16x32_bf16 a[0:3], a[172:175], v[128:131], a[0:3]
    s_addk_i32 m0, 4096
    ds_read_b128 a[152:155], v30 offset:8192
    v_and_or_b32 v154, v73, s40, v19
    v_mfma_f32_16x16x32_bf16 a[0:3], a[176:179], v[136:139], a[0:3]
    buffer_load_dwordx4 v7, s[16:19], 0 offen offset:512 lds
    v_perm_b32 v152, v63, v62, v152
    v_mfma_f32_16x16x32_bf16 a[0:3], a[180:183], v[144:147], a[0:3]
    ds_read_b128 a[156:159], v31 offset:8192
    v_and_or_b32 v153, v74, s40, v19
    v_mfma_f32_16x16x32_bf16 a[4:7], a[168:171], v[124:127], a[4:7]
    v_perm_b32 v154, v63, v62, v154
    v_and_or_b32 v155, v75, s40, v19
    v_mfma_f32_16x16x32_bf16 a[4:7], a[172:175], v[132:135], a[4:7]
    ds_read_b128 a[160:163], v32 offset:8192
    v_perm_b32 v153, v63, v62, v153
    v_mfma_f32_16x16x32_bf16 a[4:7], a[176:179], v[140:143], a[4:7]
    v_perm_b32 v155, v63, v62, v155
    v_perm_b32 v76, v71, v47, s36
    v_mfma_f32_16x16x32_bf16 a[4:7], a[180:183], v[148:151], a[4:7]
    s_waitcnt lgkmcnt(7)
    ds_read_b128 a[164:167], v33 offset:8192
    v_perm_b32 v77, v71, v47, s37
    v_mfma_f32_16x16x32_bf16 a[8:11], a[120:123], v[120:123], a[8:11]
    s_nop 0
    v_and_or_b32 v156, v76, s40, v19
    v_lshrrev_b64 v[78:79], 4, v[76:77]
    v_mfma_f32_16x16x32_bf16 a[8:11], a[124:127], v[128:131], a[8:11]
    s_add_u32 m0, s45, 151040
    ds_read_b128 a[168:171], v30 offset:12288
    v_and_or_b32 v158, v77, s40, v19
    v_mfma_f32_16x16x32_bf16 a[8:11], a[128:131], v[136:139], a[8:11]
    buffer_load_dwordx4 v8, s[16:19], 0 offen offset:512 lds
    v_perm_b32 v156, v65, v64, v156
    v_mfma_f32_16x16x32_bf16 a[8:11], a[132:135], v[144:147], a[8:11]
    ds_read_b128 a[172:175], v31 offset:12288
    v_and_or_b32 v157, v78, s40, v19
    v_mfma_f32_16x16x32_bf16 a[12:15], a[120:123], v[124:127], a[12:15]
    v_perm_b32 v158, v65, v64, v158
    v_and_or_b32 v159, v79, s40, v19
    v_mfma_f32_16x16x32_bf16 a[12:15], a[124:127], v[132:135], a[12:15]
    ds_read_b128 a[176:179], v32 offset:12288
    v_perm_b32 v157, v65, v64, v157
    v_mfma_f32_16x16x32_bf16 a[12:15], a[128:131], v[140:143], a[12:15]
    s_add_u32 m0, s45, 155136
    v_perm_b32 v159, v65, v64, v159
    v_perm_b32 v72, v70, v46, s38
    v_mfma_f32_16x16x32_bf16 a[12:15], a[132:135], v[148:151], a[12:15]
    s_waitcnt lgkmcnt(7)
    ds_read_b128 a[180:183], v33 offset:12288
    v_perm_b32 v73, v70, v46, s39
    v_mfma_f32_16x16x32_bf16 a[16:19], a[136:139], v[120:123], a[16:19]
    buffer_load_dwordx4 v9, s[16:19], 0 offen offset:512 lds
    v_and_or_b32 v160, v72, s40, v19
    v_mfma_f32_16x16x32_bf16 a[16:19], a[140:143], v[128:131], a[16:19]
    s_nop 0
    ds_read_b128 a[120:123], v30 offset:16384
    v_lshrrev_b64 v[74:75], 4, v[72:73]
    v_mfma_f32_16x16x32_bf16 a[16:19], a[144:147], v[136:139], a[16:19]
    v_and_or_b32 v162, v73, s40, v19
    v_perm_b32 v160, v63, v62, v160
    v_mfma_f32_16x16x32_bf16 a[16:19], a[148:151], v[144:147], a[16:19]
    ds_read_b128 a[124:127], v31 offset:16384
    v_and_or_b32 v161, v74, s40, v19
    v_mfma_f32_16x16x32_bf16 a[20:23], a[136:139], v[124:127], a[20:23]
    buffer_load_dword v24, v25, s[16:19], 0 offen offset:512
    v_perm_b32 v162, v63, v62, v162
    v_mfma_f32_16x16x32_bf16 a[20:23], a[140:143], v[132:135], a[20:23]
    ds_read_b128 a[128:131], v32 offset:16384
    v_and_or_b32 v163, v75, s40, v19
    v_mfma_f32_16x16x32_bf16 a[20:23], a[144:147], v[140:143], a[20:23]
    s_add_u32 m0, s45, 159232
    v_perm_b32 v161, v63, v62, v161
    v_perm_b32 v163, v63, v62, v163
    v_mfma_f32_16x16x32_bf16 a[20:23], a[148:151], v[148:151], a[20:23]
    s_waitcnt lgkmcnt(7)
    ds_read_b128 a[132:135], v33 offset:16384
    v_perm_b32 v76, v71, v47, s38
    v_mfma_f32_16x16x32_bf16 a[24:27], a[152:155], v[120:123], a[24:27]
    buffer_load_dwordx4 v10, s[16:19], 0 offen offset:512 lds
    v_perm_b32 v77, v71, v47, s39
    v_mfma_f32_16x16x32_bf16 a[24:27], a[156:159], v[128:131], a[24:27]
    s_nop 0
    ds_read_b128 a[136:139], v30 offset:20480
    v_and_or_b32 v164, v76, s40, v19
    v_mfma_f32_16x16x32_bf16 a[24:27], a[160:163], v[136:139], a[24:27]
    v_lshrrev_b64 v[78:79], 4, v[76:77]
    v_and_or_b32 v166, v77, s40, v19
    v_mfma_f32_16x16x32_bf16 a[24:27], a[164:167], v[144:147], a[24:27]
    ds_read_b128 a[140:143], v31 offset:20480
    v_perm_b32 v164, v65, v64, v164
    v_mfma_f32_16x16x32_bf16 a[28:31], a[152:155], v[124:127], a[28:31]
    s_movk_i32 s49, 512
    v_and_or_b32 v165, v78, s40, v19
    v_perm_b32 v166, v65, v64, v166
    v_and_or_b32 v167, v79, s40, v19
    v_mfma_f32_16x16x32_bf16 a[28:31], a[156:159], v[132:135], a[28:31]
    s_mov_b32 m0, s45
    ds_read_b128 a[144:147], v32 offset:20480
    v_perm_b32 v165, v65, v64, v165
    v_mfma_f32_16x16x32_bf16 a[28:31], a[160:163], v[140:143], a[28:31]
    buffer_load_dwordx4 v11, s[16:19], s49 offen lds
    v_mfma_f32_16x16x32_bf16 a[28:31], a[164:167], v[148:151], a[28:31]
    s_waitcnt vmcnt(9) lgkmcnt(7)
    ds_read_b128 a[148:151], v33 offset:20480
    v_perm_b32 v167, v65, v64, v167
    v_mfma_f32_16x16x32_bf16 a[32:35], a[168:171], v[120:123], a[32:35]
    s_barrier
    v_mfma_f32_16x16x32_bf16 a[32:35], a[172:175], v[128:131], a[32:35]
    ds_read_b128 a[152:155], v30 offset:24576
    v_lshlrev_b32_e64 v84, 16, v50
    v_mfma_f32_16x16x32_bf16 a[32:35], a[176:179], v[136:139], a[32:35]
    v_lshlrev_b32_e64 v85, 16, v51
    v_mul_f32_e64 v80, v85, v84
    v_mfma_f32_16x16x32_bf16 a[32:35], a[180:183], v[144:147], a[32:35]
    ds_read_b128 a[156:159], v31 offset:24576
    v_sub_f32_e64 v81, v84, v80
    v_mfma_f32_16x16x32_bf16 a[36:39], a[168:171], v[124:127], a[36:39]
    v_lshrrev_b64 v[70:71], 2, v[48:49]
    v_perm_b32 v72, v70, v48, s36
    v_mfma_f32_16x16x32_bf16 a[36:39], a[172:175], v[132:135], a[36:39]
    s_add_u32 m0, s45, 3584
    ds_read_b128 a[160:163], v32 offset:24576
    v_perm_b32 v73, v70, v48, s37
    v_mfma_f32_16x16x32_bf16 a[36:39], a[176:179], v[140:143], a[36:39]
    buffer_load_dwordx4 v12, s[16:19], 0 offen offset:512 lds
    v_and_or_b32 v168, v72, s40, v19
    v_mfma_f32_16x16x32_bf16 a[36:39], a[180:183], v[148:151], a[36:39]
    s_waitcnt lgkmcnt(7)
    ds_read_b128 a[164:167], v33 offset:24576
    v_lshrrev_b64 v[74:75], 4, v[72:73]
    v_mfma_f32_16x16x32_bf16 a[40:43], a[120:123], v[120:123], a[40:43]
    s_nop 0
    v_and_or_b32 v170, v73, s40, v19
    v_perm_b32 v168, v63, v62, v168
    v_mfma_f32_16x16x32_bf16 a[40:43], a[124:127], v[128:131], a[40:43]
    ds_read_b128 a[168:171], v30 offset:28672
    v_and_or_b32 v169, v74, s40, v19
    v_mfma_f32_16x16x32_bf16 a[40:43], a[128:131], v[136:139], a[40:43]
    buffer_load_dwordx2 v[40:41], v17, s[20:23], 0 offen
    v_perm_b32 v170, v63, v62, v170
    v_mfma_f32_16x16x32_bf16 a[40:43], a[132:135], v[144:147], a[40:43]
    s_add_u32 m0, s45, 7680
    ds_read_b128 a[172:175], v31 offset:28672
    v_and_or_b32 v171, v75, s40, v19
    v_mfma_f32_16x16x32_bf16 a[44:47], a[120:123], v[124:127], a[44:47]
    buffer_load_dwordx4 v13, s[16:19], 0 offen offset:512 lds
    v_perm_b32 v169, v63, v62, v169
    v_mfma_f32_16x16x32_bf16 a[44:47], a[124:127], v[132:135], a[44:47]
    ds_read_b128 a[176:179], v32 offset:28672
    v_perm_b32 v171, v63, v62, v171
    v_mfma_f32_16x16x32_bf16 a[44:47], a[128:131], v[140:143], a[44:47]
    v_perm_b32 v76, v71, v49, s36
    v_perm_b32 v77, v71, v49, s37
    v_mfma_f32_16x16x32_bf16 a[44:47], a[132:135], v[148:151], a[44:47]
    s_waitcnt lgkmcnt(7)
    ds_read_b128 a[180:183], v33 offset:28672
    v_and_or_b32 v172, v76, s40, v19
    v_mfma_f32_16x16x32_bf16 a[48:51], a[136:139], v[120:123], a[48:51]
    s_nop 0
    v_lshrrev_b64 v[78:79], 4, v[76:77]
    v_and_or_b32 v174, v77, s40, v19
    v_mfma_f32_16x16x32_bf16 a[48:51], a[140:143], v[128:131], a[48:51]
    ds_read_b128 a[120:123], v30 offset:32768
    v_perm_b32 v172, v65, v64, v172
    v_mfma_f32_16x16x32_bf16 a[48:51], a[144:147], v[136:139], a[48:51]
    v_and_or_b32 v173, v78, s40, v19
    v_perm_b32 v174, v65, v64, v174
    v_mfma_f32_16x16x32_bf16 a[48:51], a[148:151], v[144:147], a[48:51]
    s_add_u32 m0, s45, 11776
    ds_read_b128 a[124:127], v31 offset:32768
    v_and_or_b32 v175, v79, s40, v19
    v_mfma_f32_16x16x32_bf16 a[52:55], a[136:139], v[124:127], a[52:55]
    buffer_load_dwordx4 v14, s[16:19], 0 offen offset:512 lds
    v_perm_b32 v173, v65, v64, v173
    v_mfma_f32_16x16x32_bf16 a[52:55], a[140:143], v[132:135], a[52:55]
    ds_read_b128 a[128:131], v32 offset:32768
    v_perm_b32 v175, v65, v64, v175
    v_mfma_f32_16x16x32_bf16 a[52:55], a[144:147], v[140:143], a[52:55]
    v_fma_f32 v82, 2.0, v84, -v80
    v_fma_f32 v83, s41, v84, -v80
    v_mfma_f32_16x16x32_bf16 a[52:55], a[148:151], v[148:151], a[52:55]
    s_waitcnt lgkmcnt(7)
    ds_read_b128 a[132:135], v33 offset:32768
    v_cvt_pk_bf16_f32 v80, -v80, v81
    v_mfma_f32_16x16x32_bf16 a[56:59], a[152:155], v[120:123], a[56:59]
    s_nop 0
    v_cvt_pk_bf16_f32 v82, v82, v83
    v_perm_b32 v54, v82, v80, s42
    v_mfma_f32_16x16x32_bf16 a[56:59], a[156:159], v[128:131], a[56:59]
    s_add_u32 m0, s45, 15872
    ds_read_b128 a[136:139], v30 offset:36864
    v_perm_b32 v72, v70, v48, s38
    v_mfma_f32_16x16x32_bf16 a[56:59], a[160:163], v[136:139], a[56:59]
    buffer_load_dwordx4 v15, s[16:19], 0 offen offset:512 lds
    v_perm_b32 v73, v70, v48, s39
    v_mfma_f32_16x16x32_bf16 a[56:59], a[164:167], v[144:147], a[56:59]
    ds_read_b128 a[140:143], v31 offset:36864
    v_and_or_b32 v176, v72, s40, v19
    v_mfma_f32_16x16x32_bf16 a[60:63], a[152:155], v[124:127], a[60:63]
    v_lshrrev_b64 v[74:75], 4, v[72:73]
    v_and_or_b32 v178, v73, s40, v19
    v_mfma_f32_16x16x32_bf16 a[60:63], a[156:159], v[132:135], a[60:63]
    ds_read_b128 a[144:147], v32 offset:36864
    v_perm_b32 v176, v63, v62, v176
    v_mfma_f32_16x16x32_bf16 a[60:63], a[160:163], v[140:143], a[60:63]
    v_and_or_b32 v177, v74, s40, v19
    v_perm_b32 v178, v63, v62, v178
    v_mfma_f32_16x16x32_bf16 a[60:63], a[164:167], v[148:151], a[60:63]
    s_waitcnt lgkmcnt(7)
    ds_read_b128 a[148:151], v33 offset:36864
    v_and_or_b32 v179, v75, s40, v19
    v_mfma_f32_16x16x32_bf16 a[64:67], a[168:171], v[120:123], a[64:67]
    s_nop 0
    v_perm_b32 v177, v63, v62, v177
    v_perm_b32 v179, v63, v62, v179
    v_mfma_f32_16x16x32_bf16 a[64:67], a[172:175], v[128:131], a[64:67]
    s_add_u32 m0, s45, 19712
    ds_read_b128 a[152:155], v30 offset:40960
    v_perm_b32 v76, v71, v49, s38
    v_mfma_f32_16x16x32_bf16 a[64:67], a[176:179], v[136:139], a[64:67]
    buffer_load_dwordx4 v1, s[16:19], 0 offen offset:768 lds
    v_perm_b32 v77, v71, v49, s39
    v_mfma_f32_16x16x32_bf16 a[64:67], a[180:183], v[144:147], a[64:67]
    ds_read_b128 a[156:159], v31 offset:40960
    v_and_or_b32 v180, v76, s40, v19
    v_mfma_f32_16x16x32_bf16 a[68:71], a[168:171], v[124:127], a[68:71]
    v_lshrrev_b64 v[78:79], 4, v[76:77]
    v_and_or_b32 v182, v77, s40, v19
    v_mfma_f32_16x16x32_bf16 a[68:71], a[172:175], v[132:135], a[68:71]
    ds_read_b128 a[160:163], v32 offset:40960
    v_perm_b32 v180, v65, v64, v180
    v_and_or_b32 v181, v78, s40, v19
    v_mfma_f32_16x16x32_bf16 a[68:71], a[176:179], v[140:143], a[68:71]
    s_add_u32 m0, s45, 23808
    v_perm_b32 v182, v65, v64, v182
    v_and_or_b32 v183, v79, s40, v19
    v_mfma_f32_16x16x32_bf16 a[68:71], a[180:183], v[148:151], a[68:71]
    s_waitcnt lgkmcnt(7)
    ds_read_b128 a[164:167], v33 offset:40960
    v_perm_b32 v181, v65, v64, v181
    v_mfma_f32_16x16x32_bf16 a[72:75], a[120:123], v[120:123], a[72:75]
    buffer_load_dwordx4 v2, s[16:19], 0 offen offset:768 lds
    v_perm_b32 v183, v65, v64, v183
    v_mfma_f32_16x16x32_bf16 a[72:75], a[124:127], v[128:131], a[72:75]
    s_nop 0
    ds_read_b128 a[168:171], v30 offset:45056
    v_perm_b32 v58, v82, v80, s42
    v_mfma_f32_16x16x32_bf16 a[72:75], a[128:131], v[136:139], a[72:75]
    v_perm_b32 v55, v82, v80, s43
    v_perm_b32 v59, v82, v80, s43
    v_mfma_f32_16x16x32_bf16 a[72:75], a[132:135], v[144:147], a[72:75]
    ds_read_b128 a[172:175], v31 offset:45056
    v_and_b32 v84, 0xffff0000, v50
    v_mfma_f32_16x16x32_bf16 a[76:79], a[120:123], v[124:127], a[76:79]
    s_waitcnt vmcnt(13)
    v_and_b32 v85, 0xffff0000, v51
    v_lshrrev_b64 v[70:71], 2, v[38:39]
    v_mfma_f32_16x16x32_bf16 a[76:79], a[124:127], v[132:135], a[76:79]
    s_nop 0
    ds_read_b128 a[176:179], v32 offset:45056
    v_perm_b32 v72, v70, v38, s36
    v_mfma_f32_16x16x32_bf16 a[76:79], a[128:131], v[140:143], a[76:79]
    s_add_u32 m0, s45, 27904
    v_perm_b32 v73, v70, v38, s37
    v_and_or_b32 v184, v72, s40, v19
    v_mfma_f32_16x16x32_bf16 a[76:79], a[132:135], v[148:151], a[76:79]
    s_waitcnt lgkmcnt(7)
    ds_read_b128 a[180:183], v33 offset:45056
    v_lshrrev_b64 v[74:75], 4, v[72:73]
    v_mfma_f32_16x16x32_bf16 a[80:83], a[136:139], v[120:123], a[80:83]
L_padA1:
    s_cbranch_vccnz L_padA5
    s_nop 0
    buffer_load_dwordx4 v3, s[16:19], 0 offen offset:768 lds
    v_and_or_b32 v186, v73, s40, v19
    v_mfma_f32_16x16x32_bf16 a[80:83], a[140:143], v[128:131], a[80:83]
    s_mov_b64 s[20:21], s[72:73]
    ds_read_b128 a[120:123], v30 offset:49152
    v_perm_b32 v184, v67, v66, v184
    v_mfma_f32_16x16x32_bf16 a[80:83], a[144:147], v[136:139], a[80:83]
    buffer_load_dwordx2 v[42:43], v16, s[20:23], 0 offen
    v_and_or_b32 v185, v74, s40, v19
    v_mfma_f32_16x16x32_bf16 a[80:83], a[148:151], v[144:147], a[80:83]
    ds_read_b128 a[124:127], v31 offset:49152
    v_perm_b32 v186, v67, v66, v186
    v_mfma_f32_16x16x32_bf16 a[84:87], a[136:139], v[124:127], a[84:87]
    v_and_or_b32 v187, v75, s40, v19
    v_perm_b32 v185, v67, v66, v185
    v_mfma_f32_16x16x32_bf16 a[84:87], a[140:143], v[132:135], a[84:87]
    s_add_u32 m0, s45, 32000
    ds_read_b128 a[128:131], v32 offset:49152
    v_perm_b32 v187, v67, v66, v187
    v_mfma_f32_16x16x32_bf16 a[84:87], a[144:147], v[140:143], a[84:87]
    buffer_load_dwordx4 v4, s[16:19], 0 offen offset:768 lds
    v_perm_b32 v76, v71, v39, s36
    v_mfma_f32_16x16x32_bf16 a[84:87], a[148:151], v[148:151], a[84:87]
    s_waitcnt lgkmcnt(7)
    ds_read_b128 a[132:135], v33 offset:49152
    v_perm_b32 v77, v71, v39, s37
    v_mfma_f32_16x16x32_bf16 a[88:91], a[152:155], v[120:123], a[88:91]
    s_nop 0
    v_and_or_b32 v188, v76, s40, v19
    v_lshrrev_b64 v[78:79], 4, v[76:77]
    v_mfma_f32_16x16x32_bf16 a[88:91], a[156:159], v[128:131], a[88:91]
    ds_read_b128 a[136:139], v30 offset:53248
    v_and_or_b32 v190, v77, s40, v19
    v_mfma_f32_16x16x32_bf16 a[88:91], a[160:163], v[136:139], a[88:91]
    v_perm_b32 v188, v69, v68, v188
    v_and_or_b32 v189, v78, s40, v19
    v_mfma_f32_16x16x32_bf16 a[88:91], a[164:167], v[144:147], a[88:91]
    ds_read_b128 a[140:143], v31 offset:53248
    v_perm_b32 v190, v69, v68, v190
    v_mfma_f32_16x16x32_bf16 a[92:95], a[152:155], v[124:127], a[92:95]
    v_and_or_b32 v191, v79, s40, v19
    v_perm_b32 v189, v69, v68, v189
    v_mfma_f32_16x16x32_bf16 a[92:95], a[156:159], v[132:135], a[92:95]
    s_add_u32 m0, s45, 36096
    ds_read_b128 a[144:147], v32 offset:53248
    v_perm_b32 v191, v69, v68, v191
    v_mfma_f32_16x16x32_bf16 a[92:95], a[160:163], v[140:143], a[92:95]
    buffer_load_dwordx4 v5, s[16:19], 0 offen offset:768 lds
    v_mul_f32_e64 v80, v85, v84
    v_mfma_f32_16x16x32_bf16 a[92:95], a[164:167], v[148:151], a[92:95]
    s_waitcnt lgkmcnt(7)
    ds_read_b128 a[148:151], v33 offset:53248
    v_sub_f32 v81, v84, v80
    v_mfma_f32_16x16x32_bf16 a[96:99], a[168:171], v[120:123], a[96:99]
    v_fma_f32 v82, 2.0, v84, -v80
    v_fma_f32 v83, s41, v84, -v80
    v_mfma_f32_16x16x32_bf16 a[96:99], a[172:175], v[128:131], a[96:99]
    ds_read_b128 a[152:155], v30 offset:57344
    v_perm_b32 v72, v70, v38, s38
    v_mfma_f32_16x16x32_bf16 a[96:99], a[176:179], v[136:139], a[96:99]
    v_perm_b32 v73, v70, v38, s39
    v_and_or_b32 v192, v72, s40, v19
    v_mfma_f32_16x16x32_bf16 a[96:99], a[180:183], v[144:147], a[96:99]
    s_add_u32 m0, s45, 40192
    ds_read_b128 a[156:159], v31 offset:57344
    v_lshrrev_b64 v[74:75], 4, v[72:73]
    v_mfma_f32_16x16x32_bf16 a[100:103], a[168:171], v[124:127], a[100:103]
    buffer_load_dwordx4 v6, s[16:19], 0 offen offset:768 lds
    v_and_or_b32 v194, v73, s40, v19
    v_mfma_f32_16x16x32_bf16 a[100:103], a[172:175], v[132:135], a[100:103]
    ds_read_b128 a[160:163], v32 offset:57344
    v_perm_b32 v192, v67, v66, v192
    v_mfma_f32_16x16x32_bf16 a[100:103], a[176:179], v[140:143], a[100:103]
    v_and_or_b32 v193, v74, s40, v19
    v_perm_b32 v194, v67, v66, v194
    v_mfma_f32_16x16x32_bf16 a[100:103], a[180:183], v[148:151], a[100:103]
    s_waitcnt lgkmcnt(7)
    ds_read_b128 a[164:167], v33 offset:57344
    v_and_or_b32 v195, v75, s40, v19
    v_mfma_f32_16x16x32_bf16 a[104:107], a[120:123], v[120:123], a[104:107]
    s_nop 0
    v_perm_b32 v193, v67, v66, v193
    v_perm_b32 v195, v67, v66, v195
    v_mfma_f32_16x16x32_bf16 a[104:107], a[124:127], v[128:131], a[104:107]
    ds_read_b128 a[168:171], v30 offset:61440
    v_perm_b32 v76, v71, v39, s38
    v_mfma_f32_16x16x32_bf16 a[104:107], a[128:131], v[136:139], a[104:107]
    v_perm_b32 v77, v71, v39, s39
    v_and_or_b32 v196, v76, s40, v19
    v_mfma_f32_16x16x32_bf16 a[104:107], a[132:135], v[144:147], a[104:107]
    s_add_u32 m0, s45, 44288
    ds_read_b128 a[172:175], v31 offset:61440
    v_lshrrev_b64 v[78:79], 4, v[76:77]
    v_mfma_f32_16x16x32_bf16 a[108:111], a[120:123], v[124:127], a[108:111]
    buffer_load_dwordx4 v7, s[16:19], 0 offen offset:768 lds
    v_and_or_b32 v198, v77, s40, v19
    v_mfma_f32_16x16x32_bf16 a[108:111], a[124:127], v[132:135], a[108:111]
    ds_read_b128 a[176:179], v32 offset:61440
    v_perm_b32 v196, v69, v68, v196
    v_and_or_b32 v197, v78, s40, v19
    v_mfma_f32_16x16x32_bf16 a[108:111], a[128:131], v[140:143], a[108:111]
    v_perm_b32 v198, v69, v68, v198
    v_and_or_b32 v199, v79, s40, v19
    v_mfma_f32_16x16x32_bf16 a[108:111], a[132:135], v[148:151], a[108:111]
    s_waitcnt lgkmcnt(7)
    ds_read_b128 a[180:183], v33 offset:61440
    v_perm_b32 v197, v69, v68, v197
    v_mfma_f32_16x16x32_bf16 v[248:251], a[136:139], v[120:123], v[248:251]
    s_nop 0
    v_perm_b32 v199, v69, v68, v199
    v_cvt_pk_bf16_f32 v80, -v80, v81
    v_mfma_f32_16x16x32_bf16 v[248:251], a[140:143], v[128:131], v[248:251]
    s_add_u32 m0, s45, 48384
    ds_read_b128 a[120:123], v34 offset:0
    v_cvt_pk_bf16_f32 v82, v82, v83
    v_mfma_f32_16x16x32_bf16 v[248:251], a[144:147], v[136:139], v[248:251]
    buffer_load_dwordx4 v8, s[16:19], 0 offen offset:768 lds
    v_perm_b32 v56, v82, v80, s42
    v_mfma_f32_16x16x32_bf16 v[248:251], a[148:151], v[144:147], v[248:251]
    s_mov_b64 s[24:25], s[88:89]
    ds_read_b128 a[124:127], v35 offset:0
    v_perm_b32 v60, v82, v80, s42
    v_mfma_f32_16x16x32_bf16 v[252:255], a[136:139], v[124:127], v[252:255]
    buffer_load_dword v52, v18, s[24:27], 0 offen
    v_perm_b32 v57, v82, v80, s43
    v_mfma_f32_16x16x32_bf16 v[252:255], a[140:143], v[132:135], v[252:255]
    s_waitcnt vmcnt(13)
    ds_read_b128 a[128:131], v36 offset:0
    v_lshrrev_b64 v[70:71], 2, v[40:41]
    v_mfma_f32_16x16x32_bf16 v[252:255], a[144:147], v[140:143], v[252:255]
    s_mov_b64 s[28:29], s[90:91]
    v_perm_b32 v72, v70, v40, s36
    v_perm_b32 v73, v70, v40, s37
    v_mfma_f32_16x16x32_bf16 v[252:255], a[148:151], v[148:151], v[252:255]
    s_waitcnt lgkmcnt(7)
    ds_read_b128 a[132:135], v37 offset:0
    v_and_or_b32 v200, v72, s40, v19
    v_mfma_f32_16x16x32_bf16 a[0:3], a[152:155], v[152:155], a[0:3]
    buffer_load_dword v53, v18, s[28:31], 0 offen
    v_lshrrev_b64 v[74:75], 4, v[72:73]
    v_mfma_f32_16x16x32_bf16 a[0:3], a[156:159], v[160:163], a[0:3]
    s_add_u32 m0, s45, 52480
    ds_read_b128 a[136:139], v34 offset:4096
    v_and_or_b32 v202, v73, s40, v19
    v_mfma_f32_16x16x32_bf16 a[0:3], a[160:163], v[168:171], a[0:3]
    buffer_load_dwordx4 v9, s[16:19], 0 offen offset:768 lds
    v_perm_b32 v200, v67, v66, v200
    v_mfma_f32_16x16x32_bf16 a[0:3], a[164:167], v[176:179], a[0:3]
    ds_read_b128 a[140:143], v35 offset:4096
    v_and_or_b32 v201, v74, s40, v19
    v_mfma_f32_16x16x32_bf16 a[4:7], a[152:155], v[156:159], a[4:7]
    buffer_load_dwordx2 v[44:45], v17, s[20:23], 0 offen
    v_perm_b32 v202, v67, v66, v202
    v_mfma_f32_16x16x32_bf16 a[4:7], a[156:159], v[164:167], a[4:7]
    ds_read_b128 a[144:147], v36 offset:4096
    v_and_or_b32 v203, v75, s40, v19
    v_mfma_f32_16x16x32_bf16 a[4:7], a[160:163], v[172:175], a[4:7]
    buffer_load_dword v24, v25, s[16:19], 0 offen offset:1024
    v_perm_b32 v201, v67, v66, v201
    v_mfma_f32_16x16x32_bf16 a[4:7], a[164:167], v[180:183], a[4:7]
    s_waitcnt vmcnt(13) lgkmcnt(7)
    ds_read_b128 a[148:151], v37 offset:4096
    v_perm_b32 v203, v67, v66, v203
    v_mfma_f32_16x16x32_bf16 a[8:11], a[168:171], v[152:155], a[8:11]
    s_barrier
    v_mfma_f32_16x16x32_bf16 a[8:11], a[172:175], v[160:163], a[8:11]
    s_add_u32 m0, s45, 56576
    ds_read_b128 a[152:155], v34 offset:8192
    v_perm_b32 v76, v71, v41, s36
    v_mfma_f32_16x16x32_bf16 a[8:11], a[176:179], v[168:171], a[8:11]
    buffer_load_dwordx4 v10, s[16:19], 0 offen offset:768 lds
    v_perm_b32 v77, v71, v41, s37
    v_mfma_f32_16x16x32_bf16 a[8:11], a[180:183], v[176:179], a[8:11]
    ds_read_b128 a[156:159], v35 offset:8192
    v_and_or_b32 v204, v76, s40, v19
    v_mfma_f32_16x16x32_bf16 a[12:15], a[168:171], v[156:159], a[12:15]
    v_lshrrev_b64 v[78:79], 4, v[76:77]
    v_and_or_b32 v206, v77, s40, v19
    v_mfma_f32_16x16x32_bf16 a[12:15], a[172:175], v[164:167], a[12:15]
    ds_read_b128 a[160:163], v36 offset:8192
    v_perm_b32 v204, v69, v68, v204
    v_mfma_f32_16x16x32_bf16 a[12:15], a[176:179], v[172:175], a[12:15]
    s_add_u32 m0, s45, 60672
    v_and_or_b32 v205, v78, s40, v19
    v_perm_b32 v206, v69, v68, v206
    v_mfma_f32_16x16x32_bf16 a[12:15], a[180:183], v[180:183], a[12:15]
    s_waitcnt lgkmcnt(7)
    ds_read_b128 a[164:167], v37 offset:8192
    v_and_or_b32 v207, v79, s40, v19
    v_mfma_f32_16x16x32_bf16 a[16:19], a[120:123], v[152:155], a[16:19]
    buffer_load_dwordx4 v11, s[16:19], 0 offen offset:768 lds
    v_perm_b32 v205, v69, v68, v205
    v_mfma_f32_16x16x32_bf16 a[16:19], a[124:127], v[160:163], a[16:19]
    s_nop 0
    ds_read_b128 a[168:171], v34 offset:12288
    v_perm_b32 v207, v69, v68, v207
    v_mfma_f32_16x16x32_bf16 a[16:19], a[128:131], v[168:171], a[16:19]
    v_perm_b32 v61, v82, v80, s43
    v_perm_b32 v72, v70, v40, s38
    v_mfma_f32_16x16x32_bf16 a[16:19], a[132:135], v[176:179], a[16:19]
    ds_read_b128 a[172:175], v35 offset:12288
    v_perm_b32 v73, v70, v40, s39
    v_mfma_f32_16x16x32_bf16 a[20:23], a[120:123], v[156:159], a[20:23]
    v_permlane16_swap_b32_e64 v54, v58
    v_mfma_f32_16x16x32_bf16 a[20:23], a[124:127], v[164:167], a[20:23]
    s_add_u32 m0, s45, 64768
    ds_read_b128 a[176:179], v36 offset:12288
    v_and_or_b32 v208, v72, s40, v19
    v_mfma_f32_16x16x32_bf16 a[20:23], a[128:131], v[172:175], a[20:23]
    buffer_load_dwordx4 v12, s[16:19], 0 offen offset:768 lds
    v_lshrrev_b64 v[74:75], 4, v[72:73]
    v_mfma_f32_16x16x32_bf16 a[20:23], a[132:135], v[180:183], a[20:23]
    s_waitcnt lgkmcnt(7)
    ds_read_b128 a[180:183], v37 offset:12288
    v_and_or_b32 v210, v73, s40, v19
    v_mfma_f32_16x16x32_bf16 a[24:27], a[136:139], v[152:155], a[24:27]
    s_nop 0
    v_permlane16_swap_b32_e64 v55, v59
    v_mfma_f32_16x16x32_bf16 a[24:27], a[140:143], v[160:163], a[24:27]
    ds_read_b128 a[120:123], v34 offset:16384
    v_perm_b32 v208, v67, v66, v208
    v_mfma_f32_16x16x32_bf16 a[24:27], a[144:147], v[168:171], a[24:27]
    v_permlane16_swap_b32_e64 v56, v60
    v_mfma_f32_16x16x32_bf16 a[24:27], a[148:151], v[176:179], a[24:27]
    ds_read_b128 a[124:127], v35 offset:16384
    v_and_or_b32 v209, v74, s40, v19
    v_mfma_f32_16x16x32_bf16 a[28:31], a[136:139], v[156:159], a[28:31]
    v_permlane16_swap_b32_e64 v57, v61
    v_mfma_f32_16x16x32_bf16 a[28:31], a[140:143], v[164:167], a[28:31]
    s_add_u32 m0, s45, 68864
    ds_read_b128 a[128:131], v36 offset:16384
    v_perm_b32 v210, v67, v66, v210
    v_mfma_f32_16x16x32_bf16 a[28:31], a[144:147], v[172:175], a[28:31]
    buffer_load_dwordx4 v13, s[16:19], 0 offen offset:768 lds
    v_and_or_b32 v211, v75, s40, v19
    v_mfma_f32_16x16x32_bf16 a[28:31], a[148:151], v[180:183], a[28:31]
    s_waitcnt lgkmcnt(7)
    ds_read_b128 a[132:135], v37 offset:16384
    v_perm_b32 v209, v67, v66, v209
    v_mfma_f32_16x16x32_bf16 a[32:35], a[152:155], v[152:155], a[32:35]
    s_nop 0
    v_perm_b32 v211, v67, v66, v211
    v_perm_b32 v76, v71, v41, s38
    v_perm_b32 v77, v71, v41, s39
    v_mfma_f32_16x16x32_bf16 a[32:35], a[156:159], v[160:163], a[32:35]
    ds_read_b128 a[136:139], v34 offset:20480
    v_and_or_b32 v212, v76, s40, v19
    v_mfma_f32_16x16x32_bf16 a[32:35], a[160:163], v[168:171], a[32:35]
    v_lshrrev_b64 v[78:79], 4, v[76:77]
    v_and_or_b32 v214, v77, s40, v19
    v_mfma_f32_16x16x32_bf16 a[32:35], a[164:167], v[176:179], a[32:35]
    s_add_u32 m0, s45, 72960
    ds_read_b128 a[140:143], v35 offset:20480
    v_perm_b32 v212, v69, v68, v212
    v_mfma_f32_16x16x32_bf16 a[36:39], a[152:155], v[156:159], a[36:39]
    buffer_load_dwordx4 v14, s[16:19], 0 offen offset:768 lds
    v_and_or_b32 v213, v78, s40, v19
    v_mfma_f32_16x16x32_bf16 a[36:39], a[156:159], v[164:167], a[36:39]
    ds_read_b128 a[144:147], v36 offset:20480
    v_perm_b32 v214, v69, v68, v214
    v_mfma_f32_16x16x32_bf16 a[36:39], a[160:163], v[172:175], a[36:39]
    v_and_or_b32 v215, v79, s40, v19
    v_perm_b32 v213, v69, v68, v213
    v_mfma_f32_16x16x32_bf16 a[36:39], a[164:167], v[180:183], a[36:39]
    s_waitcnt lgkmcnt(7)
    ds_read_b128 a[148:151], v37 offset:20480
    v_perm_b32 v215, v69, v68, v215
    v_mfma_f32_16x16x32_bf16 a[40:43], a[168:171], v[152:155], a[40:43]
    s_waitcnt vmcnt(15)
    v_lshrrev_b64 v[70:71], 2, v[42:43]
    v_perm_b32 v72, v70, v42, s36
    v_mfma_f32_16x16x32_bf16 a[40:43], a[172:175], v[160:163], a[40:43]
    s_mov_b64 s[20:21], s[74:75]
    ds_read_b128 a[152:155], v34 offset:24576
    v_perm_b32 v73, v70, v42, s37
    v_mfma_f32_16x16x32_bf16 a[40:43], a[176:179], v[168:171], a[40:43]
    buffer_load_dwordx2 v[46:47], v16, s[20:23], 0 offen
    v_and_or_b32 v216, v72, s40, v19
    v_mfma_f32_16x16x32_bf16 a[40:43], a[180:183], v[176:179], a[40:43]
    s_addk_i32 m0, 4096
    ds_read_b128 a[156:159], v35 offset:24576
    v_lshrrev_b64 v[74:75], 4, v[72:73]
    v_mfma_f32_16x16x32_bf16 a[44:47], a[168:171], v[156:159], a[44:47]
    buffer_load_dwordx4 v15, s[16:19], 0 offen offset:768 lds
    v_and_or_b32 v218, v73, s40, v19
    v_mfma_f32_16x16x32_bf16 a[44:47], a[172:175], v[164:167], a[44:47]
    ds_read_b128 a[160:163], v36 offset:24576
    v_perm_b32 v216, v55, v54, v216
    v_mfma_f32_16x16x32_bf16 a[44:47], a[176:179], v[172:175], a[44:47]
    v_and_or_b32 v217, v74, s40, v19
    v_perm_b32 v218, v55, v54, v218
    v_mfma_f32_16x16x32_bf16 a[44:47], a[180:183], v[180:183], a[44:47]
    s_waitcnt lgkmcnt(7)
    ds_read_b128 a[164:167], v37 offset:24576
    v_and_or_b32 v219, v75, s40, v19
    v_mfma_f32_16x16x32_bf16 a[48:51], a[120:123], v[152:155], a[48:51]
    s_nop 0
    v_perm_b32 v217, v55, v54, v217
    v_perm_b32 v219, v55, v54, v219
    v_mfma_f32_16x16x32_bf16 a[48:51], a[124:127], v[160:163], a[48:51]
    s_add_u32 m0, s45, 80896
    ds_read_b128 a[168:171], v34 offset:28672
    v_perm_b32 v76, v71, v43, s36
    v_mfma_f32_16x16x32_bf16 a[48:51], a[128:131], v[168:171], a[48:51]
    buffer_load_dwordx4 v1, s[16:19], 0 offen offset:1024 lds
    v_perm_b32 v77, v71, v43, s37
    v_mfma_f32_16x16x32_bf16 a[48:51], a[132:135], v[176:179], a[48:51]
    ds_read_b128 a[172:175], v35 offset:28672
    v_and_or_b32 v220, v76, s40, v19
    v_mfma_f32_16x16x32_bf16 a[52:55], a[120:123], v[156:159], a[52:55]
    v_lshrrev_b64 v[78:79], 4, v[76:77]
    v_and_or_b32 v222, v77, s40, v19
    v_mfma_f32_16x16x32_bf16 a[52:55], a[124:127], v[164:167], a[52:55]
    ds_read_b128 a[176:179], v36 offset:28672
    v_perm_b32 v220, v57, v56, v220
    v_mfma_f32_16x16x32_bf16 a[52:55], a[128:131], v[172:175], a[52:55]
    v_and_or_b32 v221, v78, s40, v19
    v_perm_b32 v222, v57, v56, v222
    v_mfma_f32_16x16x32_bf16 a[52:55], a[132:135], v[180:183], a[52:55]
    s_waitcnt lgkmcnt(7)
    ds_read_b128 a[180:183], v37 offset:28672
    v_and_or_b32 v223, v79, s40, v19
    v_mfma_f32_16x16x32_bf16 a[56:59], a[136:139], v[152:155], a[56:59]
    s_nop 0
    v_perm_b32 v221, v57, v56, v221
    v_perm_b32 v223, v57, v56, v223
    v_mfma_f32_16x16x32_bf16 a[56:59], a[140:143], v[160:163], a[56:59]
    s_add_u32 m0, s45, 84992
    ds_read_b128 a[120:123], v26 offset:0
    v_perm_b32 v72, v70, v42, s38
    v_mfma_f32_16x16x32_bf16 a[56:59], a[144:147], v[168:171], a[56:59]
    buffer_load_dwordx4 v2, s[16:19], 0 offen offset:1024 lds
    v_perm_b32 v73, v70, v42, s39
    v_mfma_f32_16x16x32_bf16 a[56:59], a[148:151], v[176:179], a[56:59]
    ds_read_b128 a[124:127], v27 offset:0
    v_and_or_b32 v224, v72, s40, v19
    v_mfma_f32_16x16x32_bf16 a[60:63], a[136:139], v[156:159], a[60:63]
    v_lshrrev_b64 v[74:75], 4, v[72:73]
    v_and_or_b32 v226, v73, s40, v19
    v_mfma_f32_16x16x32_bf16 a[60:63], a[140:143], v[164:167], a[60:63]
    ds_read_b128 a[128:131], v28 offset:0
    v_perm_b32 v224, v55, v54, v224
    v_mfma_f32_16x16x32_bf16 a[60:63], a[144:147], v[172:175], a[60:63]
    s_add_u32 m0, s45, 89088
    v_and_or_b32 v225, v74, s40, v19
    v_perm_b32 v226, v55, v54, v226
    v_mfma_f32_16x16x32_bf16 a[60:63], a[148:151], v[180:183], a[60:63]
    s_waitcnt lgkmcnt(7)
    ds_read_b128 a[132:135], v29 offset:0
    v_and_or_b32 v227, v75, s40, v19
    v_mfma_f32_16x16x32_bf16 a[64:67], a[152:155], v[152:155], a[64:67]
    buffer_load_dwordx4 v3, s[16:19], 0 offen offset:1024 lds
    v_perm_b32 v225, v55, v54, v225
    v_mfma_f32_16x16x32_bf16 a[64:67], a[156:159], v[160:163], a[64:67]
    s_nop 0
    ds_read_b128 a[136:139], v26 offset:4096
    v_perm_b32 v227, v55, v54, v227
    v_mfma_f32_16x16x32_bf16 a[64:67], a[160:163], v[168:171], a[64:67]
    v_perm_b32 v76, v71, v43, s38
    v_perm_b32 v77, v71, v43, s39
    v_mfma_f32_16x16x32_bf16 a[64:67], a[164:167], v[176:179], a[64:67]
    ds_read_b128 a[140:143], v27 offset:4096
    v_and_or_b32 v228, v76, s40, v19
    v_mfma_f32_16x16x32_bf16 a[68:71], a[152:155], v[156:159], a[68:71]
    v_lshrrev_b64 v[78:79], 4, v[76:77]
    v_and_or_b32 v230, v77, s40, v19
    v_mfma_f32_16x16x32_bf16 a[68:71], a[156:159], v[164:167], a[68:71]
    ds_read_b128 a[144:147], v28 offset:4096
    v_perm_b32 v228, v57, v56, v228
    v_mfma_f32_16x16x32_bf16 a[68:71], a[160:163], v[172:175], a[68:71]
    s_add_u32 m0, s45, 93184
    v_and_or_b32 v229, v78, s40, v19
    v_perm_b32 v230, v57, v56, v230
    v_mfma_f32_16x16x32_bf16 a[68:71], a[164:167], v[180:183], a[68:71]
    s_waitcnt lgkmcnt(7)
    ds_read_b128 a[148:151], v29 offset:4096
    v_and_or_b32 v231, v79, s40, v19
    v_perm_b32 v229, v57, v56, v229
    v_mfma_f32_16x16x32_bf16 a[72:75], a[168:171], v[152:155], a[72:75]
    buffer_load_dwordx4 v4, s[16:19], 0 offen offset:1024 lds
    v_perm_b32 v231, v57, v56, v231
    v_mfma_f32_16x16x32_bf16 a[72:75], a[172:175], v[160:163], a[72:75]
    s_waitcnt vmcnt(14)
    ds_read_b128 a[152:155], v26 offset:8192
    v_lshlrev_b32_e64 v84, 16, v52
    v_mfma_f32_16x16x32_bf16 a[72:75], a[176:179], v[168:171], a[72:75]
    v_lshlrev_b32_e64 v85, 16, v53
    v_mul_f32_e64 v80, v85, v84
    v_mfma_f32_16x16x32_bf16 a[72:75], a[180:183], v[176:179], a[72:75]
    ds_read_b128 a[156:159], v27 offset:8192
    v_sub_f32_e64 v81, v84, v80
    v_mfma_f32_16x16x32_bf16 a[76:79], a[168:171], v[156:159], a[76:79]
    s_waitcnt vmcnt(12)
    v_lshrrev_b64 v[70:71], 2, v[44:45]
    v_perm_b32 v72, v70, v44, s36
    v_mfma_f32_16x16x32_bf16 a[76:79], a[172:175], v[164:167], a[76:79]
    s_addk_i32 m0, 4096
    ds_read_b128 a[160:163], v28 offset:8192
    v_perm_b32 v73, v70, v44, s37
    v_mfma_f32_16x16x32_bf16 a[76:79], a[176:179], v[172:175], a[76:79]
    buffer_load_dwordx4 v5, s[16:19], 0 offen offset:1024 lds
    v_and_or_b32 v232, v72, s40, v19
    v_mfma_f32_16x16x32_bf16 a[76:79], a[180:183], v[180:183], a[76:79]
    s_waitcnt lgkmcnt(7)
    ds_read_b128 a[164:167], v29 offset:8192
    v_lshrrev_b64 v[74:75], 4, v[72:73]
    v_mfma_f32_16x16x32_bf16 a[80:83], a[120:123], v[152:155], a[80:83]
    s_nop 0
    v_and_or_b32 v234, v73, s40, v19
    v_perm_b32 v232, v55, v54, v232
    v_mfma_f32_16x16x32_bf16 a[80:83], a[124:127], v[160:163], a[80:83]
    ds_read_b128 a[168:171], v26 offset:12288
    v_and_or_b32 v233, v74, s40, v19
    v_mfma_f32_16x16x32_bf16 a[80:83], a[128:131], v[168:171], a[80:83]
    v_perm_b32 v234, v55, v54, v234
    v_and_or_b32 v235, v75, s40, v19
    v_mfma_f32_16x16x32_bf16 a[80:83], a[132:135], v[176:179], a[80:83]
    ds_read_b128 a[172:175], v27 offset:12288
    v_perm_b32 v233, v55, v54, v233
    v_mfma_f32_16x16x32_bf16 a[84:87], a[120:123], v[156:159], a[84:87]
    buffer_load_dwordx2 v[48:49], v17, s[20:23], 0 offen
    v_perm_b32 v235, v55, v54, v235
    v_mfma_f32_16x16x32_bf16 a[84:87], a[124:127], v[164:167], a[84:87]
    s_add_u32 m0, s45, 101376
    ds_read_b128 a[176:179], v28 offset:12288
    v_perm_b32 v76, v71, v45, s36
    v_mfma_f32_16x16x32_bf16 a[84:87], a[128:131], v[172:175], a[84:87]
    buffer_load_dwordx4 v6, s[16:19], 0 offen offset:1024 lds
    v_perm_b32 v77, v71, v45, s37
    v_mfma_f32_16x16x32_bf16 a[84:87], a[132:135], v[180:183], a[84:87]
    s_waitcnt lgkmcnt(7)
    ds_read_b128 a[180:183], v29 offset:12288
    v_and_or_b32 v236, v76, s40, v19
    v_mfma_f32_16x16x32_bf16 a[88:91], a[136:139], v[152:155], a[88:91]
    s_nop 0
    v_lshrrev_b64 v[78:79], 4, v[76:77]
    v_and_or_b32 v238, v77, s40, v19
    v_mfma_f32_16x16x32_bf16 a[88:91], a[140:143], v[160:163], a[88:91]
    ds_read_b128 a[120:123], v26 offset:16384
    v_perm_b32 v236, v57, v56, v236
    v_mfma_f32_16x16x32_bf16 a[88:91], a[144:147], v[168:171], a[88:91]
    v_and_or_b32 v237, v78, s40, v19
    v_perm_b32 v238, v57, v56, v238
    v_mfma_f32_16x16x32_bf16 a[88:91], a[148:151], v[176:179], a[88:91]
    s_add_u32 m0, s45, 105472
    ds_read_b128 a[124:127], v27 offset:16384
    v_and_or_b32 v239, v79, s40, v19
    v_mfma_f32_16x16x32_bf16 a[92:95], a[136:139], v[156:159], a[92:95]
    buffer_load_dwordx4 v7, s[16:19], 0 offen offset:1024 lds
    v_perm_b32 v237, v57, v56, v237
    v_mfma_f32_16x16x32_bf16 a[92:95], a[140:143], v[164:167], a[92:95]
    ds_read_b128 a[128:131], v28 offset:16384
    v_perm_b32 v239, v57, v56, v239
    v_mfma_f32_16x16x32_bf16 a[92:95], a[144:147], v[172:175], a[92:95]
    v_fma_f32 v82, 2.0, v84, -v80
    v_fma_f32 v83, s41, v84, -v80
    v_mfma_f32_16x16x32_bf16 a[92:95], a[148:151], v[180:183], a[92:95]
    s_waitcnt lgkmcnt(7)
    ds_read_b128 a[132:135], v29 offset:16384
    v_cvt_pk_bf16_f32 v80, -v80, v81
    v_mfma_f32_16x16x32_bf16 a[96:99], a[152:155], v[152:155], a[96:99]
    buffer_load_dword v24, v25, s[16:19], 0 offen offset:1536
    v_cvt_pk_bf16_f32 v82, v82, v83
    v_mfma_f32_16x16x32_bf16 a[96:99], a[156:159], v[160:163], a[96:99]
    s_nop 0
    ds_read_b128 a[136:139], v26 offset:20480
    v_perm_b32 v62, v82, v80, s42
    v_mfma_f32_16x16x32_bf16 a[96:99], a[160:163], v[168:171], a[96:99]
    v_perm_b32 v72, v70, v44, s38
    v_perm_b32 v73, v70, v44, s39
    v_mfma_f32_16x16x32_bf16 a[96:99], a[164:167], v[176:179], a[96:99]
    s_add_u32 m0, s45, 109568
    ds_read_b128 a[140:143], v27 offset:20480
    v_and_or_b32 v240, v72, s40, v19
    v_mfma_f32_16x16x32_bf16 a[100:103], a[152:155], v[156:159], a[100:103]
    buffer_load_dwordx4 v8, s[16:19], 0 offen offset:1024 lds
    v_lshrrev_b64 v[74:75], 4, v[72:73]
    v_mfma_f32_16x16x32_bf16 a[100:103], a[156:159], v[164:167], a[100:103]
    ds_read_b128 a[144:147], v28 offset:20480
    v_and_or_b32 v242, v73, s40, v19
    v_mfma_f32_16x16x32_bf16 a[100:103], a[160:163], v[172:175], a[100:103]
    v_perm_b32 v240, v55, v54, v240
    v_and_or_b32 v241, v74, s40, v19
    v_mfma_f32_16x16x32_bf16 a[100:103], a[164:167], v[180:183], a[100:103]
    s_waitcnt vmcnt(13) lgkmcnt(7)
    ds_read_b128 a[148:151], v29 offset:20480
    v_perm_b32 v242, v55, v54, v242
    v_mfma_f32_16x16x32_bf16 a[104:107], a[168:171], v[152:155], a[104:107]
    s_barrier
    v_mfma_f32_16x16x32_bf16 a[104:107], a[172:175], v[160:163], a[104:107]
    s_add_u32 m0, s45, 113664
    ds_read_b128 a[152:155], v26 offset:24576
    v_and_or_b32 v243, v75, s40, v19
    v_mfma_f32_16x16x32_bf16 a[104:107], a[176:179], v[168:171], a[104:107]
    buffer_load_dwordx4 v9, s[16:19], 0 offen offset:1024 lds
    v_perm_b32 v241, v55, v54, v241
    v_mfma_f32_16x16x32_bf16 a[104:107], a[180:183], v[176:179], a[104:107]
    ds_read_b128 a[156:159], v27 offset:24576
    v_perm_b32 v243, v55, v54, v243
    v_mfma_f32_16x16x32_bf16 a[108:111], a[168:171], v[156:159], a[108:111]
    v_perm_b32 v76, v71, v45, s38
    v_perm_b32 v77, v71, v45, s39
    v_mfma_f32_16x16x32_bf16 a[108:111], a[172:175], v[164:167], a[108:111]
    ds_read_b128 a[160:163], v28 offset:24576
    v_and_or_b32 v244, v76, s40, v19
    v_mfma_f32_16x16x32_bf16 a[108:111], a[176:179], v[172:175], a[108:111]
    v_lshrrev_b64 v[78:79], 4, v[76:77]
    v_and_or_b32 v246, v77, s40, v19
    v_mfma_f32_16x16x32_bf16 a[108:111], a[180:183], v[180:183], a[108:111]
    s_waitcnt lgkmcnt(7)
    ds_read_b128 a[164:167], v29 offset:24576
    v_perm_b32 v244, v57, v56, v244
    v_mfma_f32_16x16x32_bf16 v[248:251], a[120:123], v[152:155], v[248:251]
    s_nop 0
    v_and_or_b32 v245, v78, s40, v19
    v_perm_b32 v246, v57, v56, v246
    v_mfma_f32_16x16x32_bf16 v[248:251], a[124:127], v[160:163], v[248:251]
    s_add_u32 m0, s45, 117504
    ds_read_b128 a[168:171], v26 offset:28672
    v_and_or_b32 v247, v79, s40, v19
    v_perm_b32 v245, v57, v56, v245
    v_mfma_f32_16x16x32_bf16 v[248:251], a[128:131], v[168:171], v[248:251]
    buffer_load_dwordx4 v1, s[16:19], 0 offen offset:1280 lds
    v_perm_b32 v247, v57, v56, v247
    v_mfma_f32_16x16x32_bf16 v[248:251], a[132:135], v[176:179], v[248:251]
    ds_read_b128 a[172:175], v27 offset:28672
    v_perm_b32 v66, v82, v80, s42
    v_mfma_f32_16x16x32_bf16 v[252:255], a[120:123], v[156:159], v[252:255]
    v_perm_b32 v63, v82, v80, s43
    v_perm_b32 v67, v82, v80, s43
    v_mfma_f32_16x16x32_bf16 v[252:255], a[124:127], v[164:167], v[252:255]
    s_waitcnt vmcnt(13)
    ds_read_b128 a[176:179], v28 offset:28672
    v_and_b32 v84, 0xffff0000, v52
    v_mfma_f32_16x16x32_bf16 v[252:255], a[128:131], v[172:175], v[252:255]
L_padA2:
    s_cbranch_vccnz L_backA
    s_nop 0
    s_addk_i32 m0, 3840
    v_and_b32 v85, 0xffff0000, v53
    v_lshrrev_b64 v[70:71], 2, v[46:47]
    v_mfma_f32_16x16x32_bf16 v[252:255], a[132:135], v[180:183], v[252:255]
    s_waitcnt lgkmcnt(7)
    ds_read_b128 a[180:183], v29 offset:28672
    v_perm_b32 v72, v70, v46, s36
    v_mfma_f32_16x16x32_bf16 a[0:3], a[136:139], v[184:187], a[0:3]
    buffer_load_dwordx4 v1, s[16:19], 0 offen offset:1536 lds
    v_perm_b32 v73, v70, v46, s37
    v_mfma_f32_16x16x32_bf16 a[0:3], a[140:143], v[192:195], a[0:3]
    s_nop 0
    ds_read_b128 a[120:123], v26 offset:32768
    v_and_or_b32 v88, v72, s40, v19
    v_mfma_f32_16x16x32_bf16 a[0:3], a[144:147], v[200:203], a[0:3]
    v_lshrrev_b64 v[74:75], 4, v[72:73]
    v_and_or_b32 v90, v73, s40, v19
    v_mfma_f32_16x16x32_bf16 a[0:3], a[148:151], v[208:211], a[0:3]
    s_mov_b64 s[20:21], s[76:77]
    ds_read_b128 a[124:127], v27 offset:32768
    v_perm_b32 v88, v59, v58, v88
    v_mfma_f32_16x16x32_bf16 a[4:7], a[136:139], v[188:191], a[4:7]
    buffer_load_dwordx2 v[38:39], v16, s[20:23], 0 offen
    v_and_or_b32 v89, v74, s40, v19
    v_mfma_f32_16x16x32_bf16 a[4:7], a[140:143], v[196:199], a[4:7]
    s_nop 0
    ds_read_b128 a[128:131], v28 offset:32768
    v_perm_b32 v90, v59, v58, v90
    v_mfma_f32_16x16x32_bf16 a[4:7], a[144:147], v[204:207], a[4:7]
    s_add_u32 m0, s45, 125184
    v_and_or_b32 v91, v75, s40, v19
    v_perm_b32 v89, v59, v58, v89
    v_mfma_f32_16x16x32_bf16 a[4:7], a[148:151], v[212:215], a[4:7]
    s_waitcnt lgkmcnt(7)
    ds_read_b128 a[132:135], v29 offset:32768
    v_perm_b32 v91, v59, v58, v91
    v_mfma_f32_16x16x32_bf16 a[8:11], a[152:155], v[184:187], a[8:11]
    buffer_load_dwordx4 v1, s[16:19], 0 offen offset:1792 lds
    v_perm_b32 v76, v71, v47, s36
    v_mfma_f32_16x16x32_bf16 a[8:11], a[156:159], v[192:195], a[8:11]
    s_nop 0
    ds_read_b128 a[136:139], v26 offset:36864
    v_perm_b32 v77, v71, v47, s37
    v_mfma_f32_16x16x32_bf16 a[8:11], a[160:163], v[200:203], a[8:11]
    v_and_or_b32 v92, v76, s40, v19
    v_lshrrev_b64 v[78:79], 4, v[76:77]
    v_mfma_f32_16x16x32_bf16 a[8:11], a[164:167], v[208:211], a[8:11]
    ds_read_b128 a[140:143], v27 offset:36864
    v_and_or_b32 v94, v77, s40, v19
    v_mfma_f32_16x16x32_bf16 a[12:15], a[152:155], v[188:191], a[12:15]
    v_perm_b32 v92, v61, v60, v92
    v_and_or_b32 v93, v78, s40, v19
    v_mfma_f32_16x16x32_bf16 a[12:15], a[156:159], v[196:199], a[12:15]
    s_add_u32 m0, s45, 129792
    ds_read_b128 a[144:147], v28 offset:36864
    v_perm_b32 v94, v61, v60, v94
    v_mfma_f32_16x16x32_bf16 a[12:15], a[160:163], v[204:207], a[12:15]
    buffer_load_dwordx4 v2, s[16:19], 0 offen offset:1280 lds
    v_and_or_b32 v95, v79, s40, v19
    v_mfma_f32_16x16x32_bf16 a[12:15], a[164:167], v[212:215], a[12:15]
    s_waitcnt lgkmcnt(7)
    ds_read_b128 a[148:151], v29 offset:36864
    v_perm_b32 v93, v61, v60, v93
    v_mfma_f32_16x16x32_bf16 a[16:19], a[168:171], v[184:187], a[16:19]
    s_nop 0
    v_perm_b32 v95, v61, v60, v95
    v_mul_f32_e64 v80, v85, v84
    v_mfma_f32_16x16x32_bf16 a[16:19], a[172:175], v[192:195], a[16:19]
    ds_read_b128 a[152:155], v26 offset:40960
    v_sub_f32_e64 v81, v84, v80
    v_mfma_f32_16x16x32_bf16 a[16:19], a[176:179], v[200:203], a[16:19]
    v_fma_f32 v82, 2.0, v84, -v80
    v_fma_f32 v83, s41, v84, -v80
    v_mfma_f32_16x16x32_bf16 a[16:19], a[180:183], v[208:211], a[16:19]
    ds_read_b128 a[156:159], v27 offset:40960
    v_perm_b32 v72, v70, v46, s38
    v_mfma_f32_16x16x32_bf16 a[20:23], a[168:171], v[188:191], a[20:23]
    v_perm_b32 v73, v70, v46, s39
    v_and_or_b32 v96, v72, s40, v19
    v_mfma_f32_16x16x32_bf16 a[20:23], a[172:175], v[196:199], a[20:23]
    s_add_u32 m0, s45, 133632
    ds_read_b128 a[160:163], v28 offset:40960
    v_lshrrev_b64 v[74:75], 4, v[72:73]
    v_mfma_f32_16x16x32_bf16 a[20:23], a[176:179], v[204:207], a[20:23]
    buffer_load_dwordx4 v2, s[16:19], 0 offen offset:1536 lds
    v_and_or_b32 v98, v73, s40, v19
    v_mfma_f32_16x16x32_bf16 a[20:23], a[180:183], v[212:215], a[20:23]
    s_waitcnt lgkmcnt(7)
    ds_read_b128 a[164:167], v29 offset:40960
    v_perm_b32 v96, v59, v58, v96
    v_mfma_f32_16x16x32_bf16 a[24:27], a[120:123], v[184:187], a[24:27]
    s_nop 0
    v_and_or_b32 v97, v74, s40, v19
    v_perm_b32 v98, v59, v58, v98
    v_mfma_f32_16x16x32_bf16 a[24:27], a[124:127], v[192:195], a[24:27]
    ds_read_b128 a[168:171], v26 offset:45056
    v_and_or_b32 v99, v75, s40, v19
    v_mfma_f32_16x16x32_bf16 a[24:27], a[128:131], v[200:203], a[24:27]
    v_perm_b32 v97, v59, v58, v97
    v_perm_b32 v99, v59, v58, v99
    v_mfma_f32_16x16x32_bf16 a[24:27], a[132:135], v[208:211], a[24:27]
    s_add_u32 m0, s45, 137472
    ds_read_b128 a[172:175], v27 offset:45056
    v_perm_b32 v76, v71, v47, s38
    v_mfma_f32_16x16x32_bf16 a[28:31], a[120:123], v[188:191], a[28:31]
    buffer_load_dwordx4 v2, s[16:19], 0 offen offset:1792 lds
    v_perm_b32 v77, v71, v47, s39
    v_mfma_f32_16x16x32_bf16 a[28:31], a[124:127], v[196:199], a[28:31]
    ds_read_b128 a[176:179], v28 offset:45056
    v_and_or_b32 v100, v76, s40, v19
    v_mfma_f32_16x16x32_bf16 a[28:31], a[128:131], v[204:207], a[28:31]
    v_lshrrev_b64 v[78:79], 4, v[76:77]
    v_and_or_b32 v102, v77, s40, v19
    v_mfma_f32_16x16x32_bf16 a[28:31], a[132:135], v[212:215], a[28:31]
    s_waitcnt lgkmcnt(7)
    ds_read_b128 a[180:183], v29 offset:45056
    v_perm_b32 v100, v61, v60, v100
    v_mfma_f32_16x16x32_bf16 a[32:35], a[136:139], v[184:187], a[32:35]
    s_nop 0
    v_and_or_b32 v101, v78, s40, v19
    v_perm_b32 v102, v61, v60, v102
    v_and_or_b32 v103, v79, s40, v19
    v_mfma_f32_16x16x32_bf16 a[32:35], a[140:143], v[192:195], a[32:35]
    ds_read_b128 a[120:123], v26 offset:49152
    v_perm_b32 v101, v61, v60, v101
    v_mfma_f32_16x16x32_bf16 a[32:35], a[144:147], v[200:203], a[32:35]
    v_perm_b32 v103, v61, v60, v103
    v_cvt_pk_bf16_f32 v80, -v80, v81
    v_mfma_f32_16x16x32_bf16 a[32:35], a[148:151], v[208:211], a[32:35]
    s_add_u32 m0, s45, 142080
    ds_read_b128 a[124:127], v27 offset:49152
    v_cvt_pk_bf16_f32 v82, v82, v83
    v_mfma_f32_16x16x32_bf16 a[36:39], a[136:139], v[188:191], a[36:39]
    buffer_load_dwordx4 v3, s[16:19], 0 offen offset:1280 lds
    v_perm_b32 v64, v82, v80, s42
    v_mfma_f32_16x16x32_bf16 a[36:39], a[140:143], v[196:199], a[36:39]
    ds_read_b128 a[128:131], v28 offset:49152
    v_perm_b32 v68, v82, v80, s42
    v_mfma_f32_16x16x32_bf16 a[36:39], a[144:147], v[204:207], a[36:39]
    buffer_load_dwordx2 v[40:41], v17, s[20:23], 0 offen
    v_perm_b32 v65, v82, v80, s43
    v_mfma_f32_16x16x32_bf16 a[36:39], a[148:151], v[212:215], a[36:39]
    s_waitcnt vmcnt(14) lgkmcnt(7)
    ds_read_b128 a[132:135], v29 offset:49152
    v_lshrrev_b64 v[70:71], 2, v[48:49]
    v_mfma_f32_16x16x32_bf16 a[40:43], a[152:155], v[184:187], a[40:43]
    s_nop 0
    v_perm_b32 v72, v70, v48, s36
    v_perm_b32 v73, v70, v48, s37
    v_mfma_f32_16x16x32_bf16 a[40:43], a[156:159], v[192:195], a[40:43]
    s_add_u32 m0, s45, 145920
    ds_read_b128 a[136:139], v26 offset:53248
    v_and_or_b32 v104, v72, s40, v19
    v_mfma_f32_16x16x32_bf16 a[40:43], a[160:163], v[200:203], a[40:43]
    buffer_load_dwordx4 v3, s[16:19], 0 offen offset:1536 lds
    v_lshrrev_b64 v[74:75], 4, v[72:73]
    v_mfma_f32_16x16x32_bf16 a[40:43], a[164:167], v[208:211], a[40:43]
    ds_read_b128 a[140:143], v27 offset:53248
    v_and_or_b32 v106, v73, s40, v19
    v_mfma_f32_16x16x32_bf16 a[44:47], a[152:155], v[188:191], a[44:47]
    v_perm_b32 v104, v59, v58, v104
    v_and_or_b32 v105, v74, s40, v19
    v_mfma_f32_16x16x32_bf16 a[44:47], a[156:159], v[196:199], a[44:47]
    ds_read_b128 a[144:147], v28 offset:53248
    v_perm_b32 v106, v59, v58, v106
    v_mfma_f32_16x16x32_bf16 a[44:47], a[160:163], v[204:207], a[44:47]
    v_and_or_b32 v107, v75, s40, v19
    v_perm_b32 v105, v59, v58, v105
    v_mfma_f32_16x16x32_bf16 a[44:47], a[164:167], v[212:215], a[44:47]
    s_waitcnt lgkmcnt(7)
    ds_read_b128 a[148:151], v29 offset:53248
    v_perm_b32 v107, v59, v58, v107
    v_mfma_f32_16x16x32_bf16 a[48:51], a[168:171], v[184:187], a[48:51]
    s_nop 0
    v_perm_b32 v76, v71, v49, s36
    v_perm_b32 v77, v71, v49, s37
    v_mfma_f32_16x16x32_bf16 a[48:51], a[172:175], v[192:195], a[48:51]
    s_add_u32 m0, s45, 149760
    ds_read_b128 a[152:155], v26 offset:57344
    v_and_or_b32 v108, v76, s40, v19
    v_mfma_f32_16x16x32_bf16 a[48:51], a[176:179], v[200:203], a[48:51]
    buffer_load_dwordx4 v3, s[16:19], 0 offen offset:1792 lds
    v_lshrrev_b64 v[78:79], 4, v[76:77]
    v_mfma_f32_16x16x32_bf16 a[48:51], a[180:183], v[208:211], a[48:51]
    ds_read_b128 a[156:159], v27 offset:57344
    v_and_or_b32 v110, v77, s40, v19
    v_mfma_f32_16x16x32_bf16 a[52:55], a[168:171], v[188:191], a[52:55]
    v_perm_b32 v108, v61, v60, v108
    v_and_or_b32 v109, v78, s40, v19
    v_mfma_f32_16x16x32_bf16 a[52:55], a[172:175], v[196:199], a[52:55]
    ds_read_b128 a[160:163], v28 offset:57344
    v_perm_b32 v110, v61, v60, v110
    v_mfma_f32_16x16x32_bf16 a[52:55], a[176:179], v[204:207], a[52:55]
    s_add_u32 m0, s45, 154368
    v_and_or_b32 v111, v79, s40, v19
    v_perm_b32 v109, v61, v60, v109
    v_mfma_f32_16x16x32_bf16 a[52:55], a[180:183], v[212:215], a[52:55]
    s_waitcnt lgkmcnt(7)
    ds_read_b128 a[164:167], v29 offset:57344
    v_perm_b32 v111, v61, v60, v111
    v_mfma_f32_16x16x32_bf16 a[56:59], a[120:123], v[184:187], a[56:59]
    buffer_load_dwordx4 v4, s[16:19], 0 offen offset:1280 lds
    v_perm_b32 v69, v82, v80, s43
    v_mfma_f32_16x16x32_bf16 a[56:59], a[124:127], v[192:195], a[56:59]
    s_nop 0
    ds_read_b128 a[168:171], v26 offset:61440
    v_perm_b32 v72, v70, v48, s38
    v_mfma_f32_16x16x32_bf16 a[56:59], a[128:131], v[200:203], a[56:59]
    v_permlane16_swap_b32_e64 v62, v66
    v_mfma_f32_16x16x32_bf16 a[56:59], a[132:135], v[208:211], a[56:59]
    ds_read_b128 a[172:175], v27 offset:61440
    v_perm_b32 v73, v70, v48, s39
    v_mfma_f32_16x16x32_bf16 a[60:63], a[120:123], v[188:191], a[60:63]
    v_permlane16_swap_b32_e64 v63, v67
    v_mfma_f32_16x16x32_bf16 a[60:63], a[124:127], v[196:199], a[60:63]
    ds_read_b128 a[176:179], v28 offset:61440
    v_and_or_b32 v112, v72, s40, v19
    v_mfma_f32_16x16x32_bf16 a[60:63], a[128:131], v[204:207], a[60:63]
    s_add_u32 m0, s45, 158208
    v_permlane16_swap_b32_e64 v64, v68
    v_mfma_f32_16x16x32_bf16 a[60:63], a[132:135], v[212:215], a[60:63]
    s_waitcnt lgkmcnt(7)
    ds_read_b128 a[180:183], v29 offset:61440
    v_lshrrev_b64 v[74:75], 4, v[72:73]
    v_mfma_f32_16x16x32_bf16 a[64:67], a[136:139], v[184:187], a[64:67]
    buffer_load_dwordx4 v4, s[16:19], 0 offen offset:1536 lds
    v_and_or_b32 v114, v73, s40, v19
    v_mfma_f32_16x16x32_bf16 a[64:67], a[140:143], v[192:195], a[64:67]
    s_nop 0
    ds_read_b128 a[120:123], v30 offset:0
    v_perm_b32 v112, v59, v58, v112
    v_mfma_f32_16x16x32_bf16 a[64:67], a[144:147], v[200:203], a[64:67]
    v_permlane16_swap_b32_e64 v65, v69
    v_mfma_f32_16x16x32_bf16 a[64:67], a[148:151], v[208:211], a[64:67]
    ds_read_b128 a[124:127], v31 offset:0
    v_and_or_b32 v113, v74, s40, v19
    v_mfma_f32_16x16x32_bf16 a[68:71], a[136:139], v[188:191], a[68:71]
    s_movk_i32 s49, 1792
    v_perm_b32 v114, v59, v58, v114
    v_and_or_b32 v115, v75, s40, v19
    v_mfma_f32_16x16x32_bf16 a[68:71], a[140:143], v[196:199], a[68:71]
    s_mov_b32 m0, s45
    ds_read_b128 a[128:131], v32 offset:0
    v_perm_b32 v113, v59, v58, v113
    v_mfma_f32_16x16x32_bf16 a[68:71], a[144:147], v[204:207], a[68:71]
    buffer_load_dwordx4 v4, s[16:19], s49 offen lds
    v_mfma_f32_16x16x32_bf16 a[68:71], a[148:151], v[212:215], a[68:71]
    s_waitcnt lgkmcnt(7)
    ds_read_b128 a[132:135], v33 offset:0
    v_perm_b32 v115, v59, v58, v115
    v_mfma_f32_16x16x32_bf16 a[72:75], a[152:155], v[184:187], a[72:75]
    s_nop 0
    v_perm_b32 v76, v71, v49, s38
    v_perm_b32 v77, v71, v49, s39
    v_mfma_f32_16x16x32_bf16 a[72:75], a[156:159], v[192:195], a[72:75]
    s_mov_b64 s[20:21], s[78:79]
    ds_read_b128 a[136:139], v30 offset:4096
    v_and_or_b32 v116, v76, s40, v19
    v_lshrrev_b64 v[78:79], 4, v[76:77]
    v_mfma_f32_16x16x32_bf16 a[72:75], a[160:163], v[200:203], a[72:75]
    buffer_load_dwordx2 v[42:43], v16, s[20:23], 0 offen
    v_and_or_b32 v118, v77, s40, v19
    v_mfma_f32_16x16x32_bf16 a[72:75], a[164:167], v[208:211], a[72:75]
    s_nop 0
    ds_read_b128 a[140:143], v31 offset:4096
    v_perm_b32 v116, v61, v60, v116
    v_mfma_f32_16x16x32_bf16 a[76:79], a[152:155], v[188:191], a[76:79]
    v_and_or_b32 v117, v78, s40, v19
    v_perm_b32 v118, v61, v60, v118
    v_mfma_f32_16x16x32_bf16 a[76:79], a[156:159], v[196:199], a[76:79]
    s_add_u32 m0, s45, 2816
    ds_read_b128 a[144:147], v32 offset:4096
    v_and_or_b32 v119, v79, s40, v19
    v_mfma_f32_16x16x32_bf16 a[76:79], a[160:163], v[204:207], a[76:79]
    buffer_load_dwordx4 v5, s[16:19], 0 offen offset:1280 lds
    v_perm_b32 v117, v61, v60, v117
    v_mfma_f32_16x16x32_bf16 a[76:79], a[164:167], v[212:215], a[76:79]
    s_waitcnt vmcnt(15) lgkmcnt(7)
    ds_read_b128 a[148:151], v33 offset:4096
    v_perm_b32 v119, v61, v60, v119
    v_mfma_f32_16x16x32_bf16 a[80:83], a[168:171], v[184:187], a[80:83]
    s_barrier
    v_mfma_f32_16x16x32_bf16 a[80:83], a[172:175], v[192:195], a[80:83]
    s_waitcnt vmcnt(13)
    ds_read_b128 a[152:155], v30 offset:8192
    v_lshrrev_b64 v[70:71], 2, v[38:39]
    v_mfma_f32_16x16x32_bf16 a[80:83], a[176:179], v[200:203], a[80:83]
    s_nop 0
    v_perm_b32 v72, v70, v38, s36
    v_perm_b32 v73, v70, v38, s37
    v_mfma_f32_16x16x32_bf16 a[80:83], a[180:183], v[208:211], a[80:83]
    s_add_u32 m0, s45, 6656
    ds_read_b128 a[156:159], v31 offset:8192
    v_and_or_b32 v120, v72, s40, v19
    v_mfma_f32_16x16x32_bf16 a[84:87], a[168:171], v[188:191], a[84:87]
    buffer_load_dwordx4 v5, s[16:19], 0 offen offset:1536 lds
    v_lshrrev_b64 v[74:75], 4, v[72:73]
    v_mfma_f32_16x16x32_bf16 a[84:87], a[172:175], v[196:199], a[84:87]
    ds_read_b128 a[160:163], v32 offset:8192
    v_and_or_b32 v122, v73, s40, v19
    v_mfma_f32_16x16x32_bf16 a[84:87], a[176:179], v[204:207], a[84:87]
    v_perm_b32 v120, v63, v62, v120
    v_and_or_b32 v121, v74, s40, v19
    v_mfma_f32_16x16x32_bf16 a[84:87], a[180:183], v[212:215], a[84:87]
    s_waitcnt lgkmcnt(7)
    ds_read_b128 a[164:167], v33 offset:8192
    v_perm_b32 v122, v63, v62, v122
    v_mfma_f32_16x16x32_bf16 a[88:91], a[120:123], v[184:187], a[88:91]
    s_nop 0
    v_and_or_b32 v123, v75, s40, v19
    v_perm_b32 v121, v63, v62, v121
    v_mfma_f32_16x16x32_bf16 a[88:91], a[124:127], v[192:195], a[88:91]
    ds_read_b128 a[168:171], v30 offset:12288
    v_perm_b32 v123, v63, v62, v123
    v_mfma_f32_16x16x32_bf16 a[88:91], a[128:131], v[200:203], a[88:91]
    v_perm_b32 v76, v71, v39, s36
    v_perm_b32 v77, v71, v39, s37
    v_mfma_f32_16x16x32_bf16 a[88:91], a[132:135], v[208:211], a[88:91]
    s_add_u32 m0, s45, 10496
    ds_read_b128 a[172:175], v31 offset:12288
    v_and_or_b32 v124, v76, s40, v19
    v_mfma_f32_16x16x32_bf16 a[92:95], a[120:123], v[188:191], a[92:95]
    buffer_load_dwordx4 v5, s[16:19], 0 offen offset:1792 lds
    v_lshrrev_b64 v[78:79], 4, v[76:77]
    v_mfma_f32_16x16x32_bf16 a[92:95], a[124:127], v[196:199], a[92:95]
    ds_read_b128 a[176:179], v32 offset:12288
    v_and_or_b32 v126, v77, s40, v19
    v_mfma_f32_16x16x32_bf16 a[92:95], a[128:131], v[204:207], a[92:95]
    v_perm_b32 v124, v65, v64, v124
    v_and_or_b32 v125, v78, s40, v19
    v_mfma_f32_16x16x32_bf16 a[92:95], a[132:135], v[212:215], a[92:95]
    s_waitcnt lgkmcnt(7)
    ds_read_b128 a[180:183], v33 offset:12288
    v_perm_b32 v126, v65, v64, v126
    v_mfma_f32_16x16x32_bf16 a[96:99], a[136:139], v[184:187], a[96:99]
    s_nop 0
    v_and_or_b32 v127, v79, s40, v19
    v_perm_b32 v125, v65, v64, v125
    v_mfma_f32_16x16x32_bf16 a[96:99], a[140:143], v[192:195], a[96:99]
    s_add_u32 m0, s45, 15104
    ds_read_b128 a[120:123], v30 offset:16384
    v_perm_b32 v127, v65, v64, v127
    v_mfma_f32_16x16x32_bf16 a[96:99], a[144:147], v[200:203], a[96:99]
    buffer_load_dwordx4 v6, s[16:19], 0 offen offset:1280 lds
    v_perm_b32 v72, v70, v38, s38
    v_mfma_f32_16x16x32_bf16 a[96:99], a[148:151], v[208:211], a[96:99]
    ds_read_b128 a[124:127], v31 offset:16384
    v_perm_b32 v73, v70, v38, s39
    v_mfma_f32_16x16x32_bf16 a[100:103], a[136:139], v[188:191], a[100:103]
    v_and_or_b32 v128, v72, s40, v19
    v_lshrrev_b64 v[74:75], 4, v[72:73]
    v_mfma_f32_16x16x32_bf16 a[100:103], a[140:143], v[196:199], a[100:103]
    ds_read_b128 a[128:131], v32 offset:16384
    v_and_or_b32 v130, v73, s40, v19
    v_mfma_f32_16x16x32_bf16 a[100:103], a[144:147], v[204:207], a[100:103]
    v_perm_b32 v128, v63, v62, v128
    v_and_or_b32 v129, v74, s40, v19
    v_mfma_f32_16x16x32_bf16 a[100:103], a[148:151], v[212:215], a[100:103]
    s_waitcnt lgkmcnt(7)
    ds_read_b128 a[132:135], v33 offset:16384
    v_perm_b32 v130, v63, v62, v130
    v_mfma_f32_16x16x32_bf16 a[104:107], a[152:155], v[184:187], a[104:107]
    s_nop 0
    v_and_or_b32 v131, v75, s40, v19
    v_perm_b32 v129, v63, v62, v129
    v_mfma_f32_16x16x32_bf16 a[104:107], a[156:159], v[192:195], a[104:107]
    s_add_u32 m0, s45, 18944
    ds_read_b128 a[136:139], v30 offset:20480
    v_perm_b32 v131, v63, v62, v131
    v_mfma_f32_16x16x32_bf16 a[104:107], a[160:163], v[200:203], a[104:107]
    buffer_load_dwordx4 v6, s[16:19], 0 offen offset:1536 lds
    v_perm_b32 v76, v71, v39, s38
    v_mfma_f32_16x16x32_bf16 a[104:107], a[164:167], v[208:211], a[104:107]
    ds_read_b128 a[140:143], v31 offset:20480
    v_perm_b32 v77, v71, v39, s39
    v_mfma_f32_16x16x32_bf16 a[108:111], a[152:155], v[188:191], a[108:111]
    buffer_load_dwordx2 v[44:45], v17, s[20:23], 0 offen
    v_and_or_b32 v132, v76, s40, v19
    v_mfma_f32_16x16x32_bf16 a[108:111], a[156:159], v[196:199], a[108:111]
    ds_read_b128 a[144:147], v32 offset:20480
    v_lshrrev_b64 v[78:79], 4, v[76:77]
    v_mfma_f32_16x16x32_bf16 a[108:111], a[160:163], v[204:207], a[108:111]
    s_add_u32 m0, s45, 22784
    v_and_or_b32 v134, v77, s40, v19
    v_perm_b32 v132, v65, v64, v132
    v_mfma_f32_16x16x32_bf16 a[108:111], a[164:167], v[212:215], a[108:111]
    s_waitcnt lgkmcnt(7)
    ds_read_b128 a[148:151], v33 offset:20480
    v_and_or_b32 v133, v78, s40, v19
    v_mfma_f32_16x16x32_bf16 v[248:251], a[168:171], v[184:187], v[248:251]
    buffer_load_dwordx4 v6, s[16:19], 0 offen offset:1792 lds
    v_perm_b32 v134, v65, v64, v134
    v_mfma_f32_16x16x32_bf16 v[248:251], a[172:175], v[192:195], v[248:251]
    s_nop 0
    ds_read_b128 a[152:155], v30 offset:24576
    v_and_or_b32 v135, v79, s40, v19
    v_mfma_f32_16x16x32_bf16 v[248:251], a[176:179], v[200:203], v[248:251]
    s_waitcnt vmcnt(13)
    v_perm_b32 v133, v65, v64, v133
    v_perm_b32 v135, v65, v64, v135
    v_lshrrev_b64 v[70:71], 2, v[40:41]
    v_mfma_f32_16x16x32_bf16 v[248:251], a[180:183], v[208:211], v[248:251]
    s_nop 0
    ds_read_b128 a[156:159], v31 offset:24576
    v_perm_b32 v72, v70, v40, s36
    v_mfma_f32_16x16x32_bf16 v[252:255], a[168:171], v[188:191], v[252:255]
    v_perm_b32 v73, v70, v40, s37
    v_and_or_b32 v136, v72, s40, v19
    v_mfma_f32_16x16x32_bf16 v[252:255], a[172:175], v[196:199], v[252:255]
    ds_read_b128 a[160:163], v32 offset:24576
    v_lshrrev_b64 v[74:75], 4, v[72:73]
    v_mfma_f32_16x16x32_bf16 v[252:255], a[176:179], v[204:207], v[252:255]
    s_add_u32 m0, s45, 27392
    v_and_or_b32 v138, v73, s40, v19
    v_perm_b32 v136, v63, v62, v136
    v_mfma_f32_16x16x32_bf16 v[252:255], a[180:183], v[212:215], v[252:255]
    s_waitcnt lgkmcnt(7)
    ds_read_b128 a[164:167], v33 offset:24576
    v_and_or_b32 v137, v74, s40, v19
    v_mfma_f32_16x16x32_bf16 a[0:3], a[120:123], v[216:219], a[0:3]
    buffer_load_dwordx4 v7, s[16:19], 0 offen offset:1280 lds
    v_perm_b32 v138, v63, v62, v138
    v_mfma_f32_16x16x32_bf16 a[0:3], a[124:127], v[224:227], a[0:3]
    s_nop 0
    ds_read_b128 a[168:171], v30 offset:28672
    v_and_or_b32 v139, v75, s40, v19
    v_mfma_f32_16x16x32_bf16 a[0:3], a[128:131], v[232:235], a[0:3]
    v_perm_b32 v137, v63, v62, v137
    v_perm_b32 v139, v63, v62, v139
    v_mfma_f32_16x16x32_bf16 a[0:3], a[132:135], v[240:243], a[0:3]
    ds_read_b128 a[172:175], v31 offset:28672
    v_perm_b32 v76, v71, v41, s36
    v_mfma_f32_16x16x32_bf16 a[4:7], a[120:123], v[220:223], a[4:7]
    v_perm_b32 v77, v71, v41, s37
    v_and_or_b32 v140, v76, s40, v19
    v_mfma_f32_16x16x32_bf16 a[4:7], a[124:127], v[228:231], a[4:7]
    s_add_u32 m0, s45, 31232
    ds_read_b128 a[176:179], v32 offset:28672
    v_lshrrev_b64 v[78:79], 4, v[76:77]
    v_mfma_f32_16x16x32_bf16 a[4:7], a[128:131], v[236:239], a[4:7]
    buffer_load_dwordx4 v7, s[16:19], 0 offen offset:1536 lds
    v_and_or_b32 v142, v77, s40, v19
    v_mfma_f32_16x16x32_bf16 a[4:7], a[132:135], v[244:247], a[4:7]
    s_waitcnt lgkmcnt(7)
    ds_read_b128 a[180:183], v33 offset:28672
    v_perm_b32 v140, v65, v64, v140
    v_mfma_f32_16x16x32_bf16 a[8:11], a[136:139], v[216:219], a[8:11]
    s_nop 0
    v_and_or_b32 v141, v78, s40, v19
    v_perm_b32 v142, v65, v64, v142
    v_mfma_f32_16x16x32_bf16 a[8:11], a[140:143], v[224:227], a[8:11]
    ds_read_b128 a[120:123], v30 offset:32768
    v_and_or_b32 v143, v79, s40, v19
    v_mfma_f32_16x16x32_bf16 a[8:11], a[144:147], v[232:235], a[8:11]
    v_perm_b32 v141, v65, v64, v141
    v_perm_b32 v143, v65, v64, v143
    v_mfma_f32_16x16x32_bf16 a[8:11], a[148:151], v[240:243], a[8:11]
    ds_read_b128 a[124:127], v31 offset:32768
    v_perm_b32 v72, v70, v40, s38
    v_mfma_f32_16x16x32_bf16 a[12:15], a[136:139], v[220:223], a[12:15]
    v_perm_b32 v73, v70, v40, s39
    v_and_or_b32 v144, v72, s40, v19
    v_mfma_f32_16x16x32_bf16 a[12:15], a[140:143], v[228:231], a[12:15]
    s_add_u32 m0, s45, 35072
    ds_read_b128 a[128:131], v32 offset:32768
    v_lshrrev_b64 v[74:75], 4, v[72:73]
    v_mfma_f32_16x16x32_bf16 a[12:15], a[144:147], v[236:239], a[12:15]
    buffer_load_dwordx4 v7, s[16:19], 0 offen offset:1792 lds
    v_and_or_b32 v146, v73, s40, v19
    v_mfma_f32_16x16x32_bf16 a[12:15], a[148:151], v[244:247], a[12:15]
    s_waitcnt lgkmcnt(7)
    ds_read_b128 a[132:135], v33 offset:32768
    v_perm_b32 v144, v63, v62, v144
    v_mfma_f32_16x16x32_bf16 a[16:19], a[152:155], v[216:219], a[16:19]
    s_nop 0
    v_and_or_b32 v145, v74, s40, v19
    v_perm_b32 v146, v63, v62, v146
    v_mfma_f32_16x16x32_bf16 a[16:19], a[156:159], v[224:227], a[16:19]
    ds_read_b128 a[136:139], v30 offset:36864
    v_and_or_b32 v147, v75, s40, v19
    v_mfma_f32_16x16x32_bf16 a[16:19], a[160:163], v[232:235], a[16:19]
    v_perm_b32 v145, v63, v62, v145
    v_perm_b32 v147, v63, v62, v147
    v_mfma_f32_16x16x32_bf16 a[16:19], a[164:167], v[240:243], a[16:19]
    s_add_u32 m0, s45, 39680
    ds_read_b128 a[140:143], v31 offset:36864
    v_perm_b32 v76, v71, v41, s38
    v_mfma_f32_16x16x32_bf16 a[20:23], a[152:155], v[220:223], a[20:23]
    buffer_load_dwordx4 v8, s[16:19], 0 offen offset:1280 lds
    v_perm_b32 v77, v71, v41, s39
    v_mfma_f32_16x16x32_bf16 a[20:23], a[156:159], v[228:231], a[20:23]
    ds_read_b128 a[144:147], v32 offset:36864
    v_and_or_b32 v148, v76, s40, v19
    v_mfma_f32_16x16x32_bf16 a[20:23], a[160:163], v[236:239], a[20:23]
    v_lshrrev_b64 v[78:79], 4, v[76:77]
    v_and_or_b32 v150, v77, s40, v19
    v_mfma_f32_16x16x32_bf16 a[20:23], a[164:167], v[244:247], a[20:23]
    s_waitcnt lgkmcnt(7)
    ds_read_b128 a[148:151], v33 offset:36864
    v_perm_b32 v148, v65, v64, v148
    v_mfma_f32_16x16x32_bf16 a[24:27], a[168:171], v[216:219], a[24:27]
    s_nop 0
    v_and_or_b32 v149, v78, s40, v19
    v_perm_b32 v150, v65, v64, v150
    v_mfma_f32_16x16x32_bf16 a[24:27], a[172:175], v[224:227], a[24:27]
    ds_read_b128 a[152:155], v30 offset:40960
    v_and_or_b32 v151, v79, s40, v19
    v_mfma_f32_16x16x32_bf16 a[24:27], a[176:179], v[232:235], a[24:27]
    s_waitcnt vmcnt(11)
    v_perm_b32 v149, v65, v64, v149
    v_perm_b32 v151, v65, v64, v151
    v_mfma_f32_16x16x32_bf16 a[24:27], a[180:183], v[240:243], a[24:27]
    s_addk_i32 m0, 3840
    ds_read_b128 a[156:159], v31 offset:40960
    v_lshrrev_b64 v[70:71], 2, v[42:43]
    v_mfma_f32_16x16x32_bf16 a[28:31], a[168:171], v[220:223], a[28:31]
    buffer_load_dwordx4 v8, s[16:19], 0 offen offset:1536 lds
    v_perm_b32 v72, v70, v42, s36
    v_mfma_f32_16x16x32_bf16 a[28:31], a[172:175], v[228:231], a[28:31]
    ds_read_b128 a[160:163], v32 offset:40960
    v_perm_b32 v73, v70, v42, s37
    v_mfma_f32_16x16x32_bf16 a[28:31], a[176:179], v[236:239], a[28:31]
    v_and_or_b32 v152, v72, s40, v19
    v_lshrrev_b64 v[74:75], 4, v[72:73]
    v_mfma_f32_16x16x32_bf16 a[28:31], a[180:183], v[244:247], a[28:31]
    s_waitcnt lgkmcnt(7)
    ds_read_b128 a[164:167], v33 offset:40960
    v_and_or_b32 v154, v73, s40, v19
    v_mfma_f32_16x16x32_bf16 a[32:35], a[120:123], v[216:219], a[32:35]
    s_nop 0
    v_perm_b32 v152, v67, v66, v152
    v_and_or_b32 v153, v74, s40, v19
    v_mfma_f32_16x16x32_bf16 a[32:35], a[124:127], v[224:227], a[32:35]
    s_add_u32 m0, s45, 47360
    ds_read_b128 a[168:171], v30 offset:45056
    v_perm_b32 v154, v67, v66, v154
    v_and_or_b32 v155, v75, s40, v19
    v_mfma_f32_16x16x32_bf16 a[32:35], a[128:131], v[232:235], a[32:35]
L_padA3:
    s_cbranch_vccnz L_backA
    s_nop 0
    buffer_load_dwordx4 v8, s[16:19], 0 offen offset:1792 lds
    v_perm_b32 v153, v67, v66, v153
    v_mfma_f32_16x16x32_bf16 a[32:35], a[132:135], v[240:243], a[32:35]
    ds_read_b128 a[172:175], v31 offset:45056
    v_perm_b32 v155, v67, v66, v155
    v_mfma_f32_16x16x32_bf16 a[36:39], a[120:123], v[220:223], a[36:39]
    v_perm_b32 v76, v71, v43, s36
    v_perm_b32 v77, v71, v43, s37
    v_mfma_f32_16x16x32_bf16 a[36:39], a[124:127], v[228:231], a[36:39]
    ds_read_b128 a[176:179], v32 offset:45056
    v_and_or_b32 v156, v76, s40, v19
    v_mfma_f32_16x16x32_bf16 a[36:39], a[128:131], v[236:239], a[36:39]
    v_lshrrev_b64 v[78:79], 4, v[76:77]
    v_and_or_b32 v158, v77, s40, v19
    v_mfma_f32_16x16x32_bf16 a[36:39], a[132:135], v[244:247], a[36:39]
    s_waitcnt lgkmcnt(7)
    ds_read_b128 a[180:183], v33 offset:45056
    v_perm_b32 v156, v69, v68, v156
    v_mfma_f32_16x16x32_bf16 a[40:43], a[136:139], v[216:219], a[40:43]
    s_nop 0
    v_and_or_b32 v157, v78, s40, v19
    v_perm_b32 v158, v69, v68, v158
    v_mfma_f32_16x16x32_bf16 a[40:43], a[140:143], v[224:227], a[40:43]
    s_add_u32 m0, s45, 51968
    ds_read_b128 a[120:123], v30 offset:49152
    v_and_or_b32 v159, v79, s40, v19
    v_mfma_f32_16x16x32_bf16 a[40:43], a[144:147], v[232:235], a[40:43]
    buffer_load_dwordx4 v9, s[16:19], 0 offen offset:1280 lds
    v_perm_b32 v157, v69, v68, v157
    v_mfma_f32_16x16x32_bf16 a[40:43], a[148:151], v[240:243], a[40:43]
    ds_read_b128 a[124:127], v31 offset:49152
    v_perm_b32 v159, v69, v68, v159
    v_mfma_f32_16x16x32_bf16 a[44:47], a[136:139], v[220:223], a[44:47]
    v_perm_b32 v72, v70, v42, s38
    v_perm_b32 v73, v70, v42, s39
    v_mfma_f32_16x16x32_bf16 a[44:47], a[140:143], v[228:231], a[44:47]
    ds_read_b128 a[128:131], v32 offset:49152
    v_and_or_b32 v160, v72, s40, v19
    v_mfma_f32_16x16x32_bf16 a[44:47], a[144:147], v[236:239], a[44:47]
    s_add_u32 m0, s45, 55808
    v_lshrrev_b64 v[74:75], 4, v[72:73]
    v_and_or_b32 v162, v73, s40, v19
    v_mfma_f32_16x16x32_bf16 a[44:47], a[148:151], v[244:247], a[44:47]
    s_waitcnt lgkmcnt(7)
    ds_read_b128 a[132:135], v33 offset:49152
    v_perm_b32 v160, v67, v66, v160
    v_mfma_f32_16x16x32_bf16 a[48:51], a[152:155], v[216:219], a[48:51]
    buffer_load_dwordx4 v9, s[16:19], 0 offen offset:1536 lds
    v_and_or_b32 v161, v74, s40, v19
    v_mfma_f32_16x16x32_bf16 a[48:51], a[156:159], v[224:227], a[48:51]
    s_nop 0
    ds_read_b128 a[136:139], v30 offset:53248
    v_perm_b32 v162, v67, v66, v162
    v_mfma_f32_16x16x32_bf16 a[48:51], a[160:163], v[232:235], a[48:51]
    v_and_or_b32 v163, v75, s40, v19
    v_perm_b32 v161, v67, v66, v161
    v_mfma_f32_16x16x32_bf16 a[48:51], a[164:167], v[240:243], a[48:51]
    ds_read_b128 a[140:143], v31 offset:53248
    v_perm_b32 v163, v67, v66, v163
    v_mfma_f32_16x16x32_bf16 a[52:55], a[152:155], v[220:223], a[52:55]
    v_perm_b32 v76, v71, v43, s38
    v_perm_b32 v77, v71, v43, s39
    v_mfma_f32_16x16x32_bf16 a[52:55], a[156:159], v[228:231], a[52:55]
    ds_read_b128 a[144:147], v32 offset:53248
    v_and_or_b32 v164, v76, s40, v19
    v_mfma_f32_16x16x32_bf16 a[52:55], a[160:163], v[236:239], a[52:55]
    v_lshrrev_b64 v[78:79], 4, v[76:77]
    v_and_or_b32 v166, v77, s40, v19
    v_mfma_f32_16x16x32_bf16 a[52:55], a[164:167], v[244:247], a[52:55]
    s_waitcnt vmcnt(14) lgkmcnt(7)
    ds_read_b128 a[148:151], v33 offset:53248
    v_perm_b32 v164, v69, v68, v164
    v_mfma_f32_16x16x32_bf16 a[56:59], a[168:171], v[216:219], a[56:59]
    s_barrier
    v_mfma_f32_16x16x32_bf16 a[56:59], a[172:175], v[224:227], a[56:59]
    s_add_u32 m0, s45, 59648
    ds_read_b128 a[152:155], v30 offset:57344
    v_and_or_b32 v165, v78, s40, v19
    v_mfma_f32_16x16x32_bf16 a[56:59], a[176:179], v[232:235], a[56:59]
    buffer_load_dwordx4 v9, s[16:19], 0 offen offset:1792 lds
    v_perm_b32 v166, v69, v68, v166
    v_mfma_f32_16x16x32_bf16 a[56:59], a[180:183], v[240:243], a[56:59]
    ds_read_b128 a[156:159], v31 offset:57344
    v_and_or_b32 v167, v79, s40, v19
    v_mfma_f32_16x16x32_bf16 a[60:63], a[168:171], v[220:223], a[60:63]
    s_waitcnt vmcnt(10)
    v_perm_b32 v165, v69, v68, v165
    v_perm_b32 v167, v69, v68, v167
    v_mfma_f32_16x16x32_bf16 a[60:63], a[172:175], v[228:231], a[60:63]
    s_addk_i32 m0, 4864
    ds_read_b128 a[160:163], v32 offset:57344
    v_lshrrev_b64 v[70:71], 2, v[44:45]
    v_mfma_f32_16x16x32_bf16 a[60:63], a[176:179], v[236:239], a[60:63]
    buffer_load_dwordx4 v10, s[16:19], 0 offen offset:1024 lds
    v_perm_b32 v72, v70, v44, s36
    v_mfma_f32_16x16x32_bf16 a[60:63], a[180:183], v[244:247], a[60:63]
    s_waitcnt lgkmcnt(7)
    ds_read_b128 a[164:167], v33 offset:57344
    v_perm_b32 v73, v70, v44, s37
    v_mfma_f32_16x16x32_bf16 a[64:67], a[120:123], v[216:219], a[64:67]
    s_nop 0
    v_and_or_b32 v168, v72, s40, v19
    v_lshrrev_b64 v[74:75], 4, v[72:73]
    v_mfma_f32_16x16x32_bf16 a[64:67], a[124:127], v[224:227], a[64:67]
    ds_read_b128 a[168:171], v30 offset:61440
    v_and_or_b32 v170, v73, s40, v19
    v_mfma_f32_16x16x32_bf16 a[64:67], a[128:131], v[232:235], a[64:67]
    v_perm_b32 v168, v67, v66, v168
    v_and_or_b32 v169, v74, s40, v19
    v_mfma_f32_16x16x32_bf16 a[64:67], a[132:135], v[240:243], a[64:67]
    ds_read_b128 a[172:175], v31 offset:61440
    v_perm_b32 v170, v67, v66, v170
    v_mfma_f32_16x16x32_bf16 a[68:71], a[120:123], v[220:223], a[68:71]
    v_and_or_b32 v171, v75, s40, v19
    v_perm_b32 v169, v67, v66, v169
    v_mfma_f32_16x16x32_bf16 a[68:71], a[124:127], v[228:231], a[68:71]
    s_add_u32 m0, s45, 68352
    ds_read_b128 a[176:179], v32 offset:61440
    v_perm_b32 v171, v67, v66, v171
    v_mfma_f32_16x16x32_bf16 a[68:71], a[128:131], v[236:239], a[68:71]
    buffer_load_dwordx4 v10, s[16:19], 0 offen offset:1280 lds
    v_perm_b32 v76, v71, v45, s36
    v_mfma_f32_16x16x32_bf16 a[68:71], a[132:135], v[244:247], a[68:71]
    s_waitcnt lgkmcnt(7)
    ds_read_b128 a[180:183], v33 offset:61440
    v_perm_b32 v77, v71, v45, s37
    v_mfma_f32_16x16x32_bf16 a[0:3], a[136:139], v[88:91], a[0:3]
    s_nop 0
    v_and_or_b32 v172, v76, s40, v19
    v_lshrrev_b64 v[78:79], 4, v[76:77]
    v_and_or_b32 v174, v77, s40, v19
    v_mfma_f32_16x16x32_bf16 a[0:3], a[140:143], v[96:99], a[0:3]
    ds_read_b128 a[120:123], v34 offset:0
    v_perm_b32 v172, v69, v68, v172
    v_mfma_f32_16x16x32_bf16 a[0:3], a[144:147], v[104:107], a[0:3]
    v_and_or_b32 v173, v78, s40, v19
    v_perm_b32 v174, v69, v68, v174
    v_mfma_f32_16x16x32_bf16 a[0:3], a[148:151], v[112:115], a[0:3]
    s_add_u32 m0, s45, 72192
    ds_read_b128 a[124:127], v35 offset:0
    v_and_or_b32 v175, v79, s40, v19
    v_mfma_f32_16x16x32_bf16 a[4:7], a[136:139], v[92:95], a[4:7]
    buffer_load_dwordx4 v10, s[16:19], 0 offen offset:1536 lds
    v_perm_b32 v173, v69, v68, v173
    v_mfma_f32_16x16x32_bf16 a[4:7], a[140:143], v[100:103], a[4:7]
    ds_read_b128 a[128:131], v36 offset:0
    v_perm_b32 v175, v69, v68, v175
    v_mfma_f32_16x16x32_bf16 a[4:7], a[144:147], v[108:111], a[4:7]
    v_perm_b32 v72, v70, v44, s38
    v_perm_b32 v73, v70, v44, s39
    v_mfma_f32_16x16x32_bf16 a[4:7], a[148:151], v[116:119], a[4:7]
    s_waitcnt lgkmcnt(7)
    ds_read_b128 a[132:135], v37 offset:0
    v_and_or_b32 v176, v72, s40, v19
    v_mfma_f32_16x16x32_bf16 a[4:7], a[152:155], v[124:127], a[4:7]
    s_nop 0
    v_lshrrev_b64 v[74:75], 4, v[72:73]
    v_and_or_b32 v178, v73, s40, v19
    v_mfma_f32_16x16x32_bf16 a[4:7], a[156:159], v[132:135], a[4:7]
    ds_read_b128 a[136:139], v34 offset:4096
    v_perm_b32 v176, v67, v66, v176
    v_mfma_f32_16x16x32_bf16 a[4:7], a[160:163], v[140:143], a[4:7]
    v_and_or_b32 v177, v74, s40, v19
    v_perm_b32 v178, v67, v66, v178
    v_mfma_f32_16x16x32_bf16 a[4:7], a[164:167], v[148:151], a[4:7]
    s_add_u32 m0, s45, 76032
    ds_read_b128 a[140:143], v35 offset:4096
    v_and_or_b32 v179, v75, s40, v19
    v_mfma_f32_16x16x32_bf16 a[0:3], a[152:155], v[120:123], a[0:3]
    buffer_load_dwordx4 v10, s[16:19], 0 offen offset:1792 lds
    v_perm_b32 v177, v67, v66, v177
    v_mfma_f32_16x16x32_bf16 a[0:3], a[156:159], v[128:131], a[0:3]
    ds_read_b128 a[144:147], v36 offset:4096
    v_perm_b32 v179, v67, v66, v179
    v_mfma_f32_16x16x32_bf16 a[0:3], a[160:163], v[136:139], a[0:3]
    v_perm_b32 v76, v71, v45, s38
    v_perm_b32 v77, v71, v45, s39
    v_mfma_f32_16x16x32_bf16 a[0:3], a[164:167], v[144:147], a[0:3]
    s_waitcnt lgkmcnt(7)
    ds_read_b128 a[148:151], v37 offset:4096
    v_and_or_b32 v180, v76, s40, v19
    v_mfma_f32_16x16x32_bf16 a[0:3], a[168:171], v[152:155], a[0:3]
    s_nop 0
    v_lshrrev_b64 v[78:79], 4, v[76:77]
    v_and_or_b32 v182, v77, s40, v19
    v_mfma_f32_16x16x32_bf16 a[0:3], a[172:175], v[160:163], a[0:3]
    s_add_u32 m0, s45, 80896
    ds_read_b128 a[152:155], v34 offset:8192
    v_perm_b32 v180, v69, v68, v180
    v_mfma_f32_16x16x32_bf16 a[0:3], a[176:179], v[168:171], a[0:3]
    buffer_load_dwordx4 v11, s[16:19], 0 offen offset:1024 lds
    v_and_or_b32 v181, v78, s40, v19
    v_mfma_f32_16x16x32_bf16 a[0:3], a[180:183], v[176:179], a[0:3]
    ds_read_b128 a[156:159], v35 offset:8192
    v_perm_b32 v182, v69, v68, v182
    v_mfma_f32_16x16x32_bf16 a[4:7], a[168:171], v[156:159], a[4:7]
    v_and_or_b32 v183, v79, s40, v19
    v_perm_b32 v181, v69, v68, v181
    v_mfma_f32_16x16x32_bf16 a[4:7], a[172:175], v[164:167], a[4:7]
    ds_read_b128 a[160:163], v36 offset:8192
    v_perm_b32 v183, v69, v68, v183
    v_mfma_f32_16x16x32_bf16 a[4:7], a[176:179], v[172:175], a[4:7]
    s_nop 0
    v_mfma_f32_16x16x32_bf16 a[4:7], a[180:183], v[180:183], a[4:7]
    s_waitcnt lgkmcnt(7)
    ds_read_b128 a[164:167], v37 offset:8192
    v_mfma_f32_16x16x32_bf16 a[8:11], a[120:123], v[88:91], a[8:11]
    v_accvgpr_read_b32 v38, a0
    v_accvgpr_read_b32 v39, a1
    v_mfma_f32_16x16x32_bf16 a[8:11], a[124:127], v[96:99], a[8:11]
    s_add_u32 m0, s45, 84736
    ds_read_b128 a[168:171], v34 offset:12288
    v_accvgpr_read_b32 v40, a2
    v_mfma_f32_16x16x32_bf16 a[8:11], a[128:131], v[104:107], a[8:11]
    buffer_load_dwordx4 v11, s[16:19], 0 offen offset:1280 lds
    v_accvgpr_read_b32 v41, a3
    v_mfma_f32_16x16x32_bf16 a[8:11], a[132:135], v[112:115], a[8:11]
    ds_read_b128 a[172:175], v35 offset:12288
    v_accvgpr_read_b32 v42, a4
    v_mfma_f32_16x16x32_bf16 a[12:15], a[120:123], v[92:95], a[12:15]
    v_accvgpr_read_b32 v43, a5
    v_accvgpr_read_b32 v44, a6
    v_mfma_f32_16x16x32_bf16 a[12:15], a[124:127], v[100:103], a[12:15]
    ds_read_b128 a[176:179], v36 offset:12288
    v_accvgpr_read_b32 v45, a7
    v_mfma_f32_16x16x32_bf16 a[12:15], a[128:131], v[108:111], a[12:15]
    s_add_u32 m0, s45, 88576
    v_cvt_pk_bf16_f32 v38, v38, v42
    v_cvt_pk_bf16_f32 v39, v39, v43
    v_mfma_f32_16x16x32_bf16 a[12:15], a[132:135], v[116:119], a[12:15]
    s_waitcnt lgkmcnt(7)
    ds_read_b128 a[180:183], v37 offset:12288
    v_cvt_pk_bf16_f32 v40, v40, v44
    v_mfma_f32_16x16x32_bf16 a[12:15], a[136:139], v[124:127], a[12:15]
    buffer_load_dwordx4 v11, s[16:19], 0 offen offset:1536 lds
    v_cvt_pk_bf16_f32 v41, v41, v45
    v_mfma_f32_16x16x32_bf16 a[12:15], a[140:143], v[132:135], a[12:15]
    s_add_u32 s8, s47, 0
    ds_read_b128 a[120:123], v34 offset:16384
    v_mfma_f32_16x16x32_bf16 a[12:15], a[144:147], v[140:143], a[12:15]
    buffer_store_dword v38, v20, s[32:35], s8 offen sc1
    v_mfma_f32_16x16x32_bf16 a[12:15], a[148:151], v[148:151], a[12:15]
    ds_read_b128 a[124:127], v35 offset:16384
    v_mfma_f32_16x16x32_bf16 a[8:11], a[136:139], v[120:123], a[8:11]
    v_mfma_f32_16x16x32_bf16 a[8:11], a[140:143], v[128:131], a[8:11]
    ds_read_b128 a[128:131], v36 offset:16384
    v_mfma_f32_16x16x32_bf16 a[8:11], a[144:147], v[136:139], a[8:11]
    s_add_u32 m0, s45, 92416
    v_mfma_f32_16x16x32_bf16 a[8:11], a[148:151], v[144:147], a[8:11]
    s_waitcnt lgkmcnt(7)
    ds_read_b128 a[132:135], v37 offset:16384
    v_mfma_f32_16x16x32_bf16 a[8:11], a[152:155], v[152:155], a[8:11]
    buffer_load_dwordx4 v11, s[16:19], 0 offen offset:1792 lds
    v_mfma_f32_16x16x32_bf16 a[8:11], a[156:159], v[160:163], a[8:11]
    s_nop 0
    ds_read_b128 a[136:139], v34 offset:20480
    v_mfma_f32_16x16x32_bf16 a[8:11], a[160:163], v[168:171], a[8:11]
    buffer_store_dword v39, v21, s[32:35], s8 offen sc1
    v_mfma_f32_16x16x32_bf16 a[8:11], a[164:167], v[176:179], a[8:11]
    ds_read_b128 a[140:143], v35 offset:20480
    v_mfma_f32_16x16x32_bf16 a[12:15], a[152:155], v[156:159], a[12:15]
    v_mfma_f32_16x16x32_bf16 a[12:15], a[156:159], v[164:167], a[12:15]
    s_add_u32 m0, s45, 97280
    ds_read_b128 a[144:147], v36 offset:20480
    v_mfma_f32_16x16x32_bf16 a[12:15], a[160:163], v[172:175], a[12:15]
    buffer_load_dwordx4 v12, s[16:19], 0 offen offset:1024 lds
    v_mfma_f32_16x16x32_bf16 a[12:15], a[164:167], v[180:183], a[12:15]
    s_waitcnt lgkmcnt(7)
    ds_read_b128 a[148:151], v37 offset:20480
    v_mfma_f32_16x16x32_bf16 a[16:19], a[168:171], v[88:91], a[16:19]
    buffer_store_dword v40, v22, s[32:35], s8 offen sc1
    v_mfma_f32_16x16x32_bf16 a[16:19], a[172:175], v[96:99], a[16:19]
    s_nop 0
    ds_read_b128 a[152:155], v34 offset:24576
    v_accvgpr_read_b32 v46, a8
    v_mfma_f32_16x16x32_bf16 a[16:19], a[176:179], v[104:107], a[16:19]
    v_accvgpr_read_b32 v47, a9
    v_accvgpr_read_b32 v48, a10
    v_mfma_f32_16x16x32_bf16 a[16:19], a[180:183], v[112:115], a[16:19]
    ds_read_b128 a[156:159], v35 offset:24576
    v_accvgpr_read_b32 v49, a11
    v_mfma_f32_16x16x32_bf16 a[20:23], a[168:171], v[92:95], a[20:23]
    v_accvgpr_read_b32 v50, a12
    v_accvgpr_read_b32 v51, a13
    v_mfma_f32_16x16x32_bf16 a[20:23], a[172:175], v[100:103], a[20:23]
    s_add_u32 m0, s45, 101120
    ds_read_b128 a[160:163], v36 offset:24576
    v_accvgpr_read_b32 v52, a14
    v_mfma_f32_16x16x32_bf16 a[20:23], a[176:179], v[108:111], a[20:23]
    buffer_load_dwordx4 v12, s[16:19], 0 offen offset:1280 lds
    v_accvgpr_read_b32 v53, a15
    v_mfma_f32_16x16x32_bf16 a[20:23], a[180:183], v[116:119], a[20:23]
    s_waitcnt lgkmcnt(7)
    ds_read_b128 a[164:167], v37 offset:24576
    v_cvt_pk_bf16_f32 v46, v46, v50
    v_mfma_f32_16x16x32_bf16 a[20:23], a[120:123], v[124:127], a[20:23]
    buffer_store_dword v41, v23, s[32:35], s8 offen sc1
    v_mfma_f32_16x16x32_bf16 a[20:23], a[124:127], v[132:135], a[20:23]
    s_nop 0
    ds_read_b128 a[168:171], v34 offset:28672
    v_cvt_pk_bf16_f32 v47, v47, v51
    v_mfma_f32_16x16x32_bf16 a[20:23], a[128:131], v[140:143], a[20:23]
    v_cvt_pk_bf16_f32 v48, v48, v52
    v_cvt_pk_bf16_f32 v49, v49, v53
    v_mfma_f32_16x16x32_bf16 a[20:23], a[132:135], v[148:151], a[20:23]
    s_add_u32 m0, s45, 104960
    ds_read_b128 a[172:175], v35 offset:28672
    v_mfma_f32_16x16x32_bf16 a[16:19], a[120:123], v[120:123], a[16:19]
    buffer_load_dwordx4 v12, s[16:19], 0 offen offset:1536 lds
    v_mfma_f32_16x16x32_bf16 a[16:19], a[124:127], v[128:131], a[16:19]
    s_add_u32 s9, s47, 114688
    ds_read_b128 a[176:179], v36 offset:28672
    v_mfma_f32_16x16x32_bf16 a[16:19], a[128:131], v[136:139], a[16:19]
    buffer_store_dword v46, v20, s[32:35], s9 offen sc1
    v_mfma_f32_16x16x32_bf16 a[16:19], a[132:135], v[144:147], a[16:19]
    s_waitcnt lgkmcnt(7)
    ds_read_b128 a[180:183], v37 offset:28672
    v_mfma_f32_16x16x32_bf16 a[16:19], a[136:139], v[152:155], a[16:19]
    s_nop 0
    v_mfma_f32_16x16x32_bf16 a[16:19], a[140:143], v[160:163], a[16:19]
    ds_read_b128 a[120:123], v26 offset:0
    v_mfma_f32_16x16x32_bf16 a[16:19], a[144:147], v[168:171], a[16:19]
    v_mfma_f32_16x16x32_bf16 a[16:19], a[148:151], v[176:179], a[16:19]
    s_add_u32 m0, s45, 108800
    ds_read_b128 a[124:127], v27 offset:0
    v_mfma_f32_16x16x32_bf16 a[20:23], a[136:139], v[156:159], a[20:23]
    buffer_load_dwordx4 v12, s[16:19], 0 offen offset:1792 lds
    v_mfma_f32_16x16x32_bf16 a[20:23], a[140:143], v[164:167], a[20:23]
    ds_read_b128 a[128:131], v28 offset:0
    v_mfma_f32_16x16x32_bf16 a[20:23], a[144:147], v[172:175], a[20:23]
    buffer_store_dword v47, v21, s[32:35], s9 offen sc1
    v_mfma_f32_16x16x32_bf16 a[20:23], a[148:151], v[180:183], a[20:23]
    s_waitcnt lgkmcnt(7)
    ds_read_b128 a[132:135], v29 offset:0
    v_mfma_f32_16x16x32_bf16 a[24:27], a[152:155], v[88:91], a[24:27]
    s_nop 0
    v_accvgpr_read_b32 v54, a16
    v_accvgpr_read_b32 v55, a17
    v_mfma_f32_16x16x32_bf16 a[24:27], a[156:159], v[96:99], a[24:27]
    ds_read_b128 a[136:139], v26 offset:4096
    v_accvgpr_read_b32 v56, a18
    v_mfma_f32_16x16x32_bf16 a[24:27], a[160:163], v[104:107], a[24:27]
    v_accvgpr_read_b32 v57, a19
    v_mfma_f32_16x16x32_bf16 a[24:27], a[164:167], v[112:115], a[24:27]
    ds_read_b128 a[140:143], v27 offset:4096
    v_accvgpr_read_b32 v58, a20
    v_mfma_f32_16x16x32_bf16 a[28:31], a[152:155], v[92:95], a[28:31]
    buffer_store_dword v48, v22, s[32:35], s9 offen sc1
    v_mfma_f32_16x16x32_bf16 a[28:31], a[156:159], v[100:103], a[28:31]
    ds_read_b128 a[144:147], v28 offset:4096
    v_accvgpr_read_b32 v59, a21
    v_mfma_f32_16x16x32_bf16 a[28:31], a[160:163], v[108:111], a[28:31]
    v_accvgpr_read_b32 v60, a22
    v_accvgpr_read_b32 v61, a23
    v_mfma_f32_16x16x32_bf16 a[28:31], a[164:167], v[116:119], a[28:31]
    s_waitcnt vmcnt(21) lgkmcnt(7)
    ds_read_b128 a[148:151], v29 offset:4096
    v_cvt_pk_bf16_f32 v54, v54, v58
    v_mfma_f32_16x16x32_bf16 a[28:31], a[168:171], v[124:127], a[28:31]
    s_barrier
    v_mfma_f32_16x16x32_bf16 a[28:31], a[172:175], v[132:135], a[28:31]
    s_add_u32 m0, s45, 113664
    ds_read_b128 a[152:155], v26 offset:8192
    v_cvt_pk_bf16_f32 v55, v55, v59
    v_mfma_f32_16x16x32_bf16 a[28:31], a[176:179], v[140:143], a[28:31]
    buffer_load_dwordx4 v13, s[16:19], 0 offen offset:1024 lds
    v_cvt_pk_bf16_f32 v56, v56, v60
    v_mfma_f32_16x16x32_bf16 a[28:31], a[180:183], v[148:151], a[28:31]
    s_add_u32 s10, s47, 229376
    ds_read_b128 a[156:159], v27 offset:8192
    v_cvt_pk_bf16_f32 v57, v57, v61
    v_mfma_f32_16x16x32_bf16 a[24:27], a[168:171], v[120:123], a[24:27]
    buffer_store_dword v49, v23, s[32:35], s9 offen sc1
    v_mfma_f32_16x16x32_bf16 a[24:27], a[172:175], v[128:131], a[24:27]
    s_add_u32 m0, s45, 117504
    ds_read_b128 a[160:163], v28 offset:8192
    v_mfma_f32_16x16x32_bf16 a[24:27], a[176:179], v[136:139], a[24:27]
    buffer_load_dwordx4 v13, s[16:19], 0 offen offset:1280 lds
    v_mfma_f32_16x16x32_bf16 a[24:27], a[180:183], v[144:147], a[24:27]
    s_waitcnt lgkmcnt(7)
    ds_read_b128 a[164:167], v29 offset:8192
    v_mfma_f32_16x16x32_bf16 a[24:27], a[120:123], v[152:155], a[24:27]
    buffer_store_dword v54, v20, s[32:35], s10 offen sc1
    v_mfma_f32_16x16x32_bf16 a[24:27], a[124:127], v[160:163], a[24:27]
    s_addk_i32 m0, 3840
    ds_read_b128 a[168:171], v26 offset:12288
    v_mfma_f32_16x16x32_bf16 a[24:27], a[128:131], v[168:171], a[24:27]
    buffer_load_dwordx4 v13, s[16:19], 0 offen offset:1536 lds
    v_mfma_f32_16x16x32_bf16 a[24:27], a[132:135], v[176:179], a[24:27]
    ds_read_b128 a[172:175], v27 offset:12288
    v_mfma_f32_16x16x32_bf16 a[28:31], a[120:123], v[156:159], a[28:31]
    v_mfma_f32_16x16x32_bf16 a[28:31], a[124:127], v[164:167], a[28:31]
    ds_read_b128 a[176:179], v28 offset:12288
    v_mfma_f32_16x16x32_bf16 a[28:31], a[128:131], v[172:175], a[28:31]
    s_add_u32 m0, s45, 125184
    v_mfma_f32_16x16x32_bf16 a[28:31], a[132:135], v[180:183], a[28:31]
    s_waitcnt lgkmcnt(7)
    ds_read_b128 a[180:183], v29 offset:12288
    v_mfma_f32_16x16x32_bf16 a[32:35], a[136:139], v[88:91], a[32:35]
    buffer_load_dwordx4 v13, s[16:19], 0 offen offset:1792 lds
    v_accvgpr_read_b32 v62, a24
    v_mfma_f32_16x16x32_bf16 a[32:35], a[140:143], v[96:99], a[32:35]
    s_nop 0
    ds_read_b128 a[120:123], v26 offset:16384
    v_accvgpr_read_b32 v63, a25
    v_mfma_f32_16x16x32_bf16 a[32:35], a[144:147], v[104:107], a[32:35]
    buffer_store_dword v55, v21, s[32:35], s10 offen sc1
    v_mfma_f32_16x16x32_bf16 a[32:35], a[148:151], v[112:115], a[32:35]
    ds_read_b128 a[124:127], v27 offset:16384
    v_accvgpr_read_b32 v64, a26
    v_mfma_f32_16x16x32_bf16 a[36:39], a[136:139], v[92:95], a[36:39]
    v_accvgpr_read_b32 v65, a27
    v_accvgpr_read_b32 v66, a28
    v_mfma_f32_16x16x32_bf16 a[36:39], a[140:143], v[100:103], a[36:39]
    s_add_u32 m0, s45, 130048
    ds_read_b128 a[128:131], v28 offset:16384
    v_accvgpr_read_b32 v67, a29
    v_mfma_f32_16x16x32_bf16 a[36:39], a[144:147], v[108:111], a[36:39]
    buffer_load_dwordx4 v14, s[16:19], 0 offen offset:1024 lds
    v_accvgpr_read_b32 v68, a30
    v_mfma_f32_16x16x32_bf16 a[36:39], a[148:151], v[116:119], a[36:39]
    s_waitcnt lgkmcnt(7)
    ds_read_b128 a[132:135], v29 offset:16384
    v_accvgpr_read_b32 v69, a31
    v_mfma_f32_16x16x32_bf16 a[36:39], a[152:155], v[124:127], a[36:39]
    buffer_store_dword v56, v22, s[32:35], s10 offen sc1
    v_mfma_f32_16x16x32_bf16 a[36:39], a[156:159], v[132:135], a[36:39]
    s_nop 0
    ds_read_b128 a[136:139], v26 offset:20480
    v_cvt_pk_bf16_f32 v62, v62, v66
    v_mfma_f32_16x16x32_bf16 a[36:39], a[160:163], v[140:143], a[36:39]
    v_cvt_pk_bf16_f32 v63, v63, v67
    v_cvt_pk_bf16_f32 v64, v64, v68
    v_mfma_f32_16x16x32_bf16 a[36:39], a[164:167], v[148:151], a[36:39]
    s_add_u32 s11, s47, 344064
    ds_read_b128 a[140:143], v27 offset:20480
    v_cvt_pk_bf16_f32 v65, v65, v69
    v_mfma_f32_16x16x32_bf16 a[32:35], a[152:155], v[120:123], a[32:35]
    buffer_store_dword v62, v20, s[32:35], s11 offen sc1
    v_mfma_f32_16x16x32_bf16 a[32:35], a[156:159], v[128:131], a[32:35]
    s_add_u32 m0, s45, 133888
    ds_read_b128 a[144:147], v28 offset:20480
    v_mfma_f32_16x16x32_bf16 a[32:35], a[160:163], v[136:139], a[32:35]
    buffer_load_dwordx4 v14, s[16:19], 0 offen offset:1280 lds
    v_mfma_f32_16x16x32_bf16 a[32:35], a[164:167], v[144:147], a[32:35]
    s_waitcnt lgkmcnt(7)
    ds_read_b128 a[148:151], v29 offset:20480
    v_mfma_f32_16x16x32_bf16 a[32:35], a[168:171], v[152:155], a[32:35]
    buffer_store_dword v57, v23, s[32:35], s10 offen sc1
    v_mfma_f32_16x16x32_bf16 a[32:35], a[172:175], v[160:163], a[32:35]
    s_nop 0
    ds_read_b128 a[152:155], v26 offset:24576
    v_mfma_f32_16x16x32_bf16 a[32:35], a[176:179], v[168:171], a[32:35]
    buffer_store_dword v63, v21, s[32:35], s11 offen sc1
    v_mfma_f32_16x16x32_bf16 a[32:35], a[180:183], v[176:179], a[32:35]
    s_add_u32 m0, s45, 137728
    ds_read_b128 a[156:159], v27 offset:24576
    v_mfma_f32_16x16x32_bf16 a[36:39], a[168:171], v[156:159], a[36:39]
    buffer_load_dwordx4 v14, s[16:19], 0 offen offset:1536 lds
    v_mfma_f32_16x16x32_bf16 a[36:39], a[172:175], v[164:167], a[36:39]
    ds_read_b128 a[160:163], v28 offset:24576
    v_mfma_f32_16x16x32_bf16 a[36:39], a[176:179], v[172:175], a[36:39]
    v_mfma_f32_16x16x32_bf16 a[36:39], a[180:183], v[180:183], a[36:39]
    s_waitcnt lgkmcnt(7)
    ds_read_b128 a[164:167], v29 offset:24576
    v_mfma_f32_16x16x32_bf16 a[40:43], a[120:123], v[88:91], a[40:43]
    buffer_store_dword v64, v22, s[32:35], s11 offen sc1
    v_mfma_f32_16x16x32_bf16 a[40:43], a[124:127], v[96:99], a[40:43]
    s_nop 0
    ds_read_b128 a[168:171], v26 offset:28672
    v_accvgpr_read_b32 v38, a32
    v_mfma_f32_16x16x32_bf16 a[40:43], a[128:131], v[104:107], a[40:43]
    v_accvgpr_read_b32 v39, a33
    v_accvgpr_read_b32 v40, a34
    v_mfma_f32_16x16x32_bf16 a[40:43], a[132:135], v[112:115], a[40:43]
    s_add_u32 m0, s45, 141568
    ds_read_b128 a[172:175], v27 offset:28672
    v_accvgpr_read_b32 v41, a35
    v_mfma_f32_16x16x32_bf16 a[44:47], a[120:123], v[92:95], a[44:47]
    buffer_load_dwordx4 v14, s[16:19], 0 offen offset:1792 lds
    v_accvgpr_read_b32 v42, a36
    v_mfma_f32_16x16x32_bf16 a[44:47], a[124:127], v[100:103], a[44:47]
    ds_read_b128 a[176:179], v28 offset:28672
    v_accvgpr_read_b32 v43, a37
    v_mfma_f32_16x16x32_bf16 a[44:47], a[128:131], v[108:111], a[44:47]
    buffer_store_dword v65, v23, s[32:35], s11 offen sc1
    v_mfma_f32_16x16x32_bf16 a[44:47], a[132:135], v[116:119], a[44:47]
    s_waitcnt lgkmcnt(7)
    ds_read_b128 a[180:183], v29 offset:28672
    v_accvgpr_read_b32 v44, a38
    v_mfma_f32_16x16x32_bf16 a[44:47], a[136:139], v[124:127], a[44:47]
    s_nop 0
    v_accvgpr_read_b32 v45, a39
    v_cvt_pk_bf16_f32 v38, v38, v42
    v_mfma_f32_16x16x32_bf16 a[44:47], a[140:143], v[132:135], a[44:47]
    s_add_u32 m0, s45, 146432
    ds_read_b128 a[120:123], v26 offset:32768
    v_cvt_pk_bf16_f32 v39, v39, v43
    v_mfma_f32_16x16x32_bf16 a[44:47], a[144:147], v[140:143], a[44:47]
    buffer_load_dwordx4 v15, s[16:19], 0 offen offset:1024 lds
    v_cvt_pk_bf16_f32 v40, v40, v44
    v_mfma_f32_16x16x32_bf16 a[44:47], a[148:151], v[148:151], a[44:47]
    s_add_u32 s8, s47, 458752
    ds_read_b128 a[124:127], v27 offset:32768
    v_cvt_pk_bf16_f32 v41, v41, v45
    v_mfma_f32_16x16x32_bf16 a[40:43], a[136:139], v[120:123], a[40:43]
    buffer_store_dword v38, v20, s[32:35], s8 offen sc1
    v_mfma_f32_16x16x32_bf16 a[40:43], a[140:143], v[128:131], a[40:43]
    ds_read_b128 a[128:131], v28 offset:32768
    v_mfma_f32_16x16x32_bf16 a[40:43], a[144:147], v[136:139], a[40:43]
    v_mfma_f32_16x16x32_bf16 a[40:43], a[148:151], v[144:147], a[40:43]
    s_waitcnt lgkmcnt(7)
    ds_read_b128 a[132:135], v29 offset:32768
    v_mfma_f32_16x16x32_bf16 a[40:43], a[152:155], v[152:155], a[40:43]
    s_nop 0
    v_mfma_f32_16x16x32_bf16 a[40:43], a[156:159], v[160:163], a[40:43]
    s_add_u32 m0, s45, 150272
    ds_read_b128 a[136:139], v26 offset:36864
    v_mfma_f32_16x16x32_bf16 a[40:43], a[160:163], v[168:171], a[40:43]
    buffer_load_dwordx4 v15, s[16:19], 0 offen offset:1280 lds
    v_mfma_f32_16x16x32_bf16 a[40:43], a[164:167], v[176:179], a[40:43]
    ds_read_b128 a[140:143], v27 offset:36864
    v_mfma_f32_16x16x32_bf16 a[44:47], a[152:155], v[156:159], a[44:47]
    buffer_store_dword v39, v21, s[32:35], s8 offen sc1
    v_mfma_f32_16x16x32_bf16 a[44:47], a[156:159], v[164:167], a[44:47]
    ds_read_b128 a[144:147], v28 offset:36864
    v_mfma_f32_16x16x32_bf16 a[44:47], a[160:163], v[172:175], a[44:47]
    s_add_u32 m0, s45, 154112
    v_mfma_f32_16x16x32_bf16 a[44:47], a[164:167], v[180:183], a[44:47]
    s_waitcnt lgkmcnt(7)
    ds_read_b128 a[148:151], v29 offset:36864
    v_mfma_f32_16x16x32_bf16 a[48:51], a[168:171], v[88:91], a[48:51]
    buffer_load_dwordx4 v15, s[16:19], 0 offen offset:1536 lds
    v_accvgpr_read_b32 v46, a40
    v_mfma_f32_16x16x32_bf16 a[48:51], a[172:175], v[96:99], a[48:51]
L_padA4:
    s_cbranch_vccnz L_backA
    ds_read_b128 a[152:155], v26 offset:40960
    v_accvgpr_read_b32 v47, a41
    v_mfma_f32_16x16x32_bf16 a[48:51], a[176:179], v[104:107], a[48:51]
    buffer_store_dword v40, v22, s[32:35], s8 offen sc1
    v_mfma_f32_16x16x32_bf16 a[48:51], a[180:183], v[112:115], a[48:51]
    ds_read_b128 a[156:159], v27 offset:40960
    v_accvgpr_read_b32 v48, a42
    v_mfma_f32_16x16x32_bf16 a[52:55], a[168:171], v[92:95], a[52:55]
    v_accvgpr_read_b32 v49, a43
    v_accvgpr_read_b32 v50, a44
    v_mfma_f32_16x16x32_bf16 a[52:55], a[172:175], v[100:103], a[52:55]
    ds_read_b128 a[160:163], v28 offset:40960
    v_accvgpr_read_b32 v51, a45
    v_mfma_f32_16x16x32_bf16 a[52:55], a[176:179], v[108:111], a[52:55]
    s_add_u32 m0, s45, 157952
    v_accvgpr_read_b32 v52, a46
    v_accvgpr_read_b32 v53, a47
    v_mfma_f32_16x16x32_bf16 a[52:55], a[180:183], v[116:119], a[52:55]
    s_waitcnt lgkmcnt(7)
    ds_read_b128 a[164:167], v29 offset:40960
    v_cvt_pk_bf16_f32 v46, v46, v50
    v_mfma_f32_16x16x32_bf16 a[52:55], a[120:123], v[124:127], a[52:55]
    buffer_load_dwordx4 v15, s[16:19], 0 offen offset:1792 lds
    v_cvt_pk_bf16_f32 v47, v47, v51
    v_mfma_f32_16x16x32_bf16 a[52:55], a[124:127], v[132:135], a[52:55]
    s_nop 0
    ds_read_b128 a[168:171], v26 offset:45056
    v_cvt_pk_bf16_f32 v48, v48, v52
    v_mfma_f32_16x16x32_bf16 a[52:55], a[128:131], v[140:143], a[52:55]
    buffer_store_dword v41, v23, s[32:35], s8 offen sc1
    v_mfma_f32_16x16x32_bf16 a[52:55], a[132:135], v[148:151], a[52:55]
    s_add_u32 s9, s47, 573440
    ds_read_b128 a[172:175], v27 offset:45056
    v_cvt_pk_bf16_f32 v49, v49, v53
    v_mfma_f32_16x16x32_bf16 a[48:51], a[120:123], v[120:123], a[48:51]
    buffer_store_dword v46, v20, s[32:35], s9 offen sc1
    v_mfma_f32_16x16x32_bf16 a[48:51], a[124:127], v[128:131], a[48:51]
    ds_read_b128 a[176:179], v28 offset:45056
    v_mfma_f32_16x16x32_bf16 a[48:51], a[128:131], v[136:139], a[48:51]
    v_mfma_f32_16x16x32_bf16 a[48:51], a[132:135], v[144:147], a[48:51]
    s_waitcnt lgkmcnt(7)
    ds_read_b128 a[180:183], v29 offset:45056
    v_mfma_f32_16x16x32_bf16 a[48:51], a[136:139], v[152:155], a[48:51]
    s_nop 0
    v_mfma_f32_16x16x32_bf16 a[48:51], a[140:143], v[160:163], a[48:51]
    ds_read_b128 a[120:123], v26 offset:49152
    v_mfma_f32_16x16x32_bf16 a[48:51], a[144:147], v[168:171], a[48:51]
    buffer_store_dword v47, v21, s[32:35], s9 offen sc1
    v_mfma_f32_16x16x32_bf16 a[48:51], a[148:151], v[176:179], a[48:51]
    ds_read_b128 a[124:127], v27 offset:49152
    v_mfma_f32_16x16x32_bf16 a[52:55], a[136:139], v[156:159], a[52:55]
    v_mfma_f32_16x16x32_bf16 a[52:55], a[140:143], v[164:167], a[52:55]
    ds_read_b128 a[128:131], v28 offset:49152
    v_mfma_f32_16x16x32_bf16 a[52:55], a[144:147], v[172:175], a[52:55]
    v_mfma_f32_16x16x32_bf16 a[52:55], a[148:151], v[180:183], a[52:55]
    s_waitcnt lgkmcnt(7)
    ds_read_b128 a[132:135], v29 offset:49152
    v_mfma_f32_16x16x32_bf16 a[56:59], a[152:155], v[88:91], a[56:59]
    buffer_store_dword v48, v22, s[32:35], s9 offen sc1
    v_mfma_f32_16x16x32_bf16 a[56:59], a[156:159], v[96:99], a[56:59]
    s_nop 0
    ds_read_b128 a[136:139], v26 offset:53248
    v_accvgpr_read_b32 v54, a48
    v_mfma_f32_16x16x32_bf16 a[56:59], a[160:163], v[104:107], a[56:59]
    v_accvgpr_read_b32 v55, a49
    v_accvgpr_read_b32 v56, a50
    v_mfma_f32_16x16x32_bf16 a[56:59], a[164:167], v[112:115], a[56:59]
    ds_read_b128 a[140:143], v27 offset:53248
    v_accvgpr_read_b32 v57, a51
    v_mfma_f32_16x16x32_bf16 a[60:63], a[152:155], v[92:95], a[60:63]
    v_accvgpr_read_b32 v58, a52
    v_accvgpr_read_b32 v59, a53
    v_mfma_f32_16x16x32_bf16 a[60:63], a[156:159], v[100:103], a[60:63]
    ds_read_b128 a[144:147], v28 offset:53248
    v_accvgpr_read_b32 v60, a54
    v_mfma_f32_16x16x32_bf16 a[60:63], a[160:163], v[108:111], a[60:63]
    buffer_store_dword v49, v23, s[32:35], s9 offen sc1
    v_mfma_f32_16x16x32_bf16 a[60:63], a[164:167], v[116:119], a[60:63]
    s_waitcnt vmcnt(35) lgkmcnt(7)
    ds_read_b128 a[148:151], v29 offset:53248
    v_accvgpr_read_b32 v61, a55
    v_mfma_f32_16x16x32_bf16 a[60:63], a[168:171], v[124:127], a[60:63]
    s_barrier
    v_mfma_f32_16x16x32_bf16 a[60:63], a[172:175], v[132:135], a[60:63]
    ds_read_b128 a[152:155], v26 offset:57344
    v_cvt_pk_bf16_f32 v54, v54, v58
    v_mfma_f32_16x16x32_bf16 a[60:63], a[176:179], v[140:143], a[60:63]
    v_cvt_pk_bf16_f32 v55, v55, v59
    v_cvt_pk_bf16_f32 v56, v56, v60
    v_mfma_f32_16x16x32_bf16 a[60:63], a[180:183], v[148:151], a[60:63]
    s_add_u32 s10, s47, 688128
    ds_read_b128 a[156:159], v27 offset:57344
    v_cvt_pk_bf16_f32 v57, v57, v61
    v_mfma_f32_16x16x32_bf16 a[56:59], a[168:171], v[120:123], a[56:59]
    buffer_store_dword v54, v20, s[32:35], s10 offen sc1
    v_mfma_f32_16x16x32_bf16 a[56:59], a[172:175], v[128:131], a[56:59]
    ds_read_b128 a[160:163], v28 offset:57344
    v_mfma_f32_16x16x32_bf16 a[56:59], a[176:179], v[136:139], a[56:59]
    v_mfma_f32_16x16x32_bf16 a[56:59], a[180:183], v[144:147], a[56:59]
    s_waitcnt lgkmcnt(7)
    ds_read_b128 a[164:167], v29 offset:57344
    v_mfma_f32_16x16x32_bf16 a[56:59], a[120:123], v[152:155], a[56:59]
    s_nop 0
    v_mfma_f32_16x16x32_bf16 a[56:59], a[124:127], v[160:163], a[56:59]
    ds_read_b128 a[168:171], v26 offset:61440
    v_mfma_f32_16x16x32_bf16 a[56:59], a[128:131], v[168:171], a[56:59]
    buffer_store_dword v55, v21, s[32:35], s10 offen sc1
    v_mfma_f32_16x16x32_bf16 a[56:59], a[132:135], v[176:179], a[56:59]
    ds_read_b128 a[172:175], v27 offset:61440
    v_mfma_f32_16x16x32_bf16 a[60:63], a[120:123], v[156:159], a[60:63]
    v_mfma_f32_16x16x32_bf16 a[60:63], a[124:127], v[164:167], a[60:63]
    ds_read_b128 a[176:179], v28 offset:61440
    v_mfma_f32_16x16x32_bf16 a[60:63], a[128:131], v[172:175], a[60:63]
    v_mfma_f32_16x16x32_bf16 a[60:63], a[132:135], v[180:183], a[60:63]
    s_waitcnt lgkmcnt(7)
    ds_read_b128 a[180:183], v29 offset:61440
    v_mfma_f32_16x16x32_bf16 a[64:67], a[136:139], v[88:91], a[64:67]
    buffer_store_dword v56, v22, s[32:35], s10 offen sc1
    v_mfma_f32_16x16x32_bf16 a[64:67], a[140:143], v[96:99], a[64:67]
    s_nop 0
    ds_read_b128 a[120:123], v30 offset:0
    v_accvgpr_read_b32 v62, a56
    v_mfma_f32_16x16x32_bf16 a[64:67], a[144:147], v[104:107], a[64:67]
    v_accvgpr_read_b32 v63, a57
    v_accvgpr_read_b32 v64, a58
    v_mfma_f32_16x16x32_bf16 a[64:67], a[148:151], v[112:115], a[64:67]
    ds_read_b128 a[124:127], v31 offset:0
    v_accvgpr_read_b32 v65, a59
    v_mfma_f32_16x16x32_bf16 a[68:71], a[136:139], v[92:95], a[68:71]
    v_accvgpr_read_b32 v66, a60
    v_accvgpr_read_b32 v67, a61
    v_mfma_f32_16x16x32_bf16 a[68:71], a[140:143], v[100:103], a[68:71]
    ds_read_b128 a[128:131], v32 offset:0
    v_accvgpr_read_b32 v68, a62
    v_mfma_f32_16x16x32_bf16 a[68:71], a[144:147], v[108:111], a[68:71]
    buffer_store_dword v57, v23, s[32:35], s10 offen sc1
    v_mfma_f32_16x16x32_bf16 a[68:71], a[148:151], v[116:119], a[68:71]
    s_waitcnt lgkmcnt(7)
    ds_read_b128 a[132:135], v33 offset:0
    v_accvgpr_read_b32 v69, a63
    v_mfma_f32_16x16x32_bf16 a[68:71], a[152:155], v[124:127], a[68:71]
    s_nop 0
    v_cvt_pk_bf16_f32 v62, v62, v66
    v_cvt_pk_bf16_f32 v63, v63, v67
    v_mfma_f32_16x16x32_bf16 a[68:71], a[156:159], v[132:135], a[68:71]
    ds_read_b128 a[136:139], v30 offset:4096
    v_cvt_pk_bf16_f32 v64, v64, v68
    v_mfma_f32_16x16x32_bf16 a[68:71], a[160:163], v[140:143], a[68:71]
    v_cvt_pk_bf16_f32 v65, v65, v69
    v_mfma_f32_16x16x32_bf16 a[68:71], a[164:167], v[148:151], a[68:71]
    s_add_u32 s11, s47, 802816
    ds_read_b128 a[140:143], v31 offset:4096
    v_mfma_f32_16x16x32_bf16 a[64:67], a[152:155], v[120:123], a[64:67]
    buffer_store_dword v62, v20, s[32:35], s11 offen sc1
    v_mfma_f32_16x16x32_bf16 a[64:67], a[156:159], v[128:131], a[64:67]
    ds_read_b128 a[144:147], v32 offset:4096
    v_mfma_f32_16x16x32_bf16 a[64:67], a[160:163], v[136:139], a[64:67]
    v_mfma_f32_16x16x32_bf16 a[64:67], a[164:167], v[144:147], a[64:67]
    s_waitcnt lgkmcnt(7)
    ds_read_b128 a[148:151], v33 offset:4096
    v_mfma_f32_16x16x32_bf16 a[64:67], a[168:171], v[152:155], a[64:67]
    s_nop 0
    v_mfma_f32_16x16x32_bf16 a[64:67], a[172:175], v[160:163], a[64:67]
    ds_read_b128 a[152:155], v30 offset:8192
    v_mfma_f32_16x16x32_bf16 a[64:67], a[176:179], v[168:171], a[64:67]
    buffer_store_dword v63, v21, s[32:35], s11 offen sc1
    v_mfma_f32_16x16x32_bf16 a[64:67], a[180:183], v[176:179], a[64:67]
    ds_read_b128 a[156:159], v31 offset:8192
    v_mfma_f32_16x16x32_bf16 a[68:71], a[168:171], v[156:159], a[68:71]
    v_mfma_f32_16x16x32_bf16 a[68:71], a[172:175], v[164:167], a[68:71]
    ds_read_b128 a[160:163], v32 offset:8192
    v_mfma_f32_16x16x32_bf16 a[68:71], a[176:179], v[172:175], a[68:71]
    v_mfma_f32_16x16x32_bf16 a[68:71], a[180:183], v[180:183], a[68:71]
    s_waitcnt lgkmcnt(7)
    ds_read_b128 a[164:167], v33 offset:8192
    v_mfma_f32_16x16x32_bf16 a[72:75], a[120:123], v[216:219], a[72:75]
    buffer_store_dword v64, v22, s[32:35], s11 offen sc1
    v_mfma_f32_16x16x32_bf16 a[72:75], a[124:127], v[224:227], a[72:75]
    s_nop 0
    ds_read_b128 a[168:171], v30 offset:12288
    v_accvgpr_read_b32 v38, a64
    v_mfma_f32_16x16x32_bf16 a[72:75], a[128:131], v[232:235], a[72:75]
    v_accvgpr_read_b32 v39, a65
    v_accvgpr_read_b32 v40, a66
    v_mfma_f32_16x16x32_bf16 a[72:75], a[132:135], v[240:243], a[72:75]
    ds_read_b128 a[172:175], v31 offset:12288
    v_accvgpr_read_b32 v41, a67
    v_mfma_f32_16x16x32_bf16 a[76:79], a[120:123], v[220:223], a[76:79]
    v_accvgpr_read_b32 v42, a68
    v_accvgpr_read_b32 v43, a69
    v_mfma_f32_16x16x32_bf16 a[76:79], a[124:127], v[228:231], a[76:79]
    ds_read_b128 a[176:179], v32 offset:12288
    v_accvgpr_read_b32 v44, a70
    v_mfma_f32_16x16x32_bf16 a[76:79], a[128:131], v[236:239], a[76:79]
    buffer_store_dword v65, v23, s[32:35], s11 offen sc1
    v_mfma_f32_16x16x32_bf16 a[76:79], a[132:135], v[244:247], a[76:79]
    s_waitcnt lgkmcnt(7)
    ds_read_b128 a[180:183], v33 offset:12288
    v_accvgpr_read_b32 v45, a71
    v_mfma_f32_16x16x32_bf16 a[76:79], a[136:139], v[92:95], a[76:79]
    s_nop 0
    v_cvt_pk_bf16_f32 v38, v38, v42
    v_cvt_pk_bf16_f32 v39, v39, v43
    v_mfma_f32_16x16x32_bf16 a[76:79], a[140:143], v[100:103], a[76:79]
    ds_read_b128 a[120:123], v30 offset:16384
    v_cvt_pk_bf16_f32 v40, v40, v44
    v_mfma_f32_16x16x32_bf16 a[76:79], a[144:147], v[108:111], a[76:79]
    v_cvt_pk_bf16_f32 v41, v41, v45
    v_mfma_f32_16x16x32_bf16 a[76:79], a[148:151], v[116:119], a[76:79]
    s_add_u32 s8, s47, 917504
    ds_read_b128 a[124:127], v31 offset:16384
    v_mfma_f32_16x16x32_bf16 a[72:75], a[136:139], v[88:91], a[72:75]
    buffer_store_dword v38, v20, s[32:35], s8 offen sc1
    v_mfma_f32_16x16x32_bf16 a[72:75], a[140:143], v[96:99], a[72:75]
    ds_read_b128 a[128:131], v32 offset:16384
    v_mfma_f32_16x16x32_bf16 a[72:75], a[144:147], v[104:107], a[72:75]
    v_mfma_f32_16x16x32_bf16 a[72:75], a[148:151], v[112:115], a[72:75]
    s_waitcnt lgkmcnt(7)
    ds_read_b128 a[132:135], v33 offset:16384
    v_mfma_f32_16x16x32_bf16 a[72:75], a[152:155], v[120:123], a[72:75]
    s_nop 0
    v_mfma_f32_16x16x32_bf16 a[72:75], a[156:159], v[128:131], a[72:75]
    ds_read_b128 a[136:139], v30 offset:20480
    v_mfma_f32_16x16x32_bf16 a[72:75], a[160:163], v[136:139], a[72:75]
    v_mfma_f32_16x16x32_bf16 a[72:75], a[164:167], v[144:147], a[72:75]
    ds_read_b128 a[140:143], v31 offset:20480
    v_mfma_f32_16x16x32_bf16 a[76:79], a[152:155], v[124:127], a[76:79]
    buffer_store_dword v39, v21, s[32:35], s8 offen sc1
    v_mfma_f32_16x16x32_bf16 a[76:79], a[156:159], v[132:135], a[76:79]
    ds_read_b128 a[144:147], v32 offset:20480
    v_mfma_f32_16x16x32_bf16 a[76:79], a[160:163], v[140:143], a[76:79]
    v_mfma_f32_16x16x32_bf16 a[76:79], a[164:167], v[148:151], a[76:79]
    s_waitcnt lgkmcnt(7)
    ds_read_b128 a[148:151], v33 offset:20480
    v_mfma_f32_16x16x32_bf16 a[76:79], a[168:171], v[156:159], a[76:79]
    s_nop 0
    v_mfma_f32_16x16x32_bf16 a[76:79], a[172:175], v[164:167], a[76:79]
    ds_read_b128 a[152:155], v30 offset:24576
    v_mfma_f32_16x16x32_bf16 a[76:79], a[176:179], v[172:175], a[76:79]
    v_mfma_f32_16x16x32_bf16 a[76:79], a[180:183], v[180:183], a[76:79]
    ds_read_b128 a[156:159], v31 offset:24576
    v_mfma_f32_16x16x32_bf16 a[72:75], a[168:171], v[152:155], a[72:75]
    buffer_store_dword v40, v22, s[32:35], s8 offen sc1
    v_mfma_f32_16x16x32_bf16 a[72:75], a[172:175], v[160:163], a[72:75]
    ds_read_b128 a[160:163], v32 offset:24576
    v_mfma_f32_16x16x32_bf16 a[72:75], a[176:179], v[168:171], a[72:75]
    v_mfma_f32_16x16x32_bf16 a[72:75], a[180:183], v[176:179], a[72:75]
    s_waitcnt lgkmcnt(7)
    ds_read_b128 a[164:167], v33 offset:24576
    v_mfma_f32_16x16x32_bf16 a[80:83], a[120:123], v[216:219], a[80:83]
    s_nop 0
    v_accvgpr_read_b32 v50, a76
    v_accvgpr_read_b32 v51, a77
    v_mfma_f32_16x16x32_bf16 a[80:83], a[124:127], v[224:227], a[80:83]
    ds_read_b128 a[168:171], v30 offset:28672
    v_accvgpr_read_b32 v52, a78
    v_mfma_f32_16x16x32_bf16 a[80:83], a[128:131], v[232:235], a[80:83]
    v_accvgpr_read_b32 v53, a79
    v_mfma_f32_16x16x32_bf16 a[80:83], a[132:135], v[240:243], a[80:83]
    ds_read_b128 a[172:175], v31 offset:28672
    v_accvgpr_read_b32 v46, a72
    v_mfma_f32_16x16x32_bf16 a[84:87], a[120:123], v[220:223], a[84:87]
    buffer_store_dword v41, v23, s[32:35], s8 offen sc1
    v_mfma_f32_16x16x32_bf16 a[84:87], a[124:127], v[228:231], a[84:87]
    ds_read_b128 a[176:179], v32 offset:28672
    v_accvgpr_read_b32 v47, a73
    v_mfma_f32_16x16x32_bf16 a[84:87], a[128:131], v[236:239], a[84:87]
    v_accvgpr_read_b32 v48, a74
    v_accvgpr_read_b32 v49, a75
    v_mfma_f32_16x16x32_bf16 a[84:87], a[132:135], v[244:247], a[84:87]
    s_waitcnt lgkmcnt(7)
    ds_read_b128 a[180:183], v33 offset:28672
    v_cvt_pk_bf16_f32 v46, v46, v50
    v_mfma_f32_16x16x32_bf16 a[84:87], a[136:139], v[92:95], a[84:87]
    s_nop 0
    v_cvt_pk_bf16_f32 v47, v47, v51
    v_cvt_pk_bf16_f32 v48, v48, v52
    v_mfma_f32_16x16x32_bf16 a[84:87], a[140:143], v[100:103], a[84:87]
    s_add_u32 s9, s47, 1032192
    ds_read_b128 a[120:123], v30 offset:32768
    v_cvt_pk_bf16_f32 v49, v49, v53
    v_mfma_f32_16x16x32_bf16 a[84:87], a[144:147], v[108:111], a[84:87]
    buffer_store_dword v46, v20, s[32:35], s9 offen sc1
    v_mfma_f32_16x16x32_bf16 a[84:87], a[148:151], v[116:119], a[84:87]
    ds_read_b128 a[124:127], v31 offset:32768
    v_mfma_f32_16x16x32_bf16 a[80:83], a[136:139], v[88:91], a[80:83]
    v_mfma_f32_16x16x32_bf16 a[80:83], a[140:143], v[96:99], a[80:83]
    ds_read_b128 a[128:131], v32 offset:32768
    v_mfma_f32_16x16x32_bf16 a[80:83], a[144:147], v[104:107], a[80:83]
    v_mfma_f32_16x16x32_bf16 a[80:83], a[148:151], v[112:115], a[80:83]
    s_waitcnt lgkmcnt(7)
    ds_read_b128 a[132:135], v33 offset:32768
    v_mfma_f32_16x16x32_bf16 a[80:83], a[152:155], v[120:123], a[80:83]
    s_nop 0
    v_mfma_f32_16x16x32_bf16 a[80:83], a[156:159], v[128:131], a[80:83]
    ds_read_b128 a[136:139], v30 offset:36864
    v_mfma_f32_16x16x32_bf16 a[80:83], a[160:163], v[136:139], a[80:83]
    buffer_store_dword v47, v21, s[32:35], s9 offen sc1
    v_mfma_f32_16x16x32_bf16 a[80:83], a[164:167], v[144:147], a[80:83]
    ds_read_b128 a[140:143], v31 offset:36864
    v_mfma_f32_16x16x32_bf16 a[84:87], a[152:155], v[124:127], a[84:87]
    v_mfma_f32_16x16x32_bf16 a[84:87], a[156:159], v[132:135], a[84:87]
    ds_read_b128 a[144:147], v32 offset:36864
    v_mfma_f32_16x16x32_bf16 a[84:87], a[160:163], v[140:143], a[84:87]
    v_mfma_f32_16x16x32_bf16 a[84:87], a[164:167], v[148:151], a[84:87]
    s_waitcnt vmcnt(19) lgkmcnt(7)
    ds_read_b128 a[148:151], v33 offset:36864
    v_mfma_f32_16x16x32_bf16 a[84:87], a[168:171], v[156:159], a[84:87]
    s_barrier
    v_mfma_f32_16x16x32_bf16 a[84:87], a[172:175], v[164:167], a[84:87]
    ds_read_b128 a[152:155], v30 offset:40960
    v_mfma_f32_16x16x32_bf16 a[84:87], a[176:179], v[172:175], a[84:87]
    buffer_store_dword v48, v22, s[32:35], s9 offen sc1
    v_mfma_f32_16x16x32_bf16 a[84:87], a[180:183], v[180:183], a[84:87]
    ds_read_b128 a[156:159], v31 offset:40960
    v_mfma_f32_16x16x32_bf16 a[80:83], a[168:171], v[152:155], a[80:83]
    v_mfma_f32_16x16x32_bf16 a[80:83], a[172:175], v[160:163], a[80:83]
    ds_read_b128 a[160:163], v32 offset:40960
    v_mfma_f32_16x16x32_bf16 a[80:83], a[176:179], v[168:171], a[80:83]
    v_mfma_f32_16x16x32_bf16 a[80:83], a[180:183], v[176:179], a[80:83]
    s_waitcnt lgkmcnt(7)
    ds_read_b128 a[164:167], v33 offset:40960
    v_mfma_f32_16x16x32_bf16 a[88:91], a[120:123], v[216:219], a[88:91]
    s_nop 0
    v_accvgpr_read_b32 v58, a84
    v_accvgpr_read_b32 v59, a85
    v_mfma_f32_16x16x32_bf16 a[88:91], a[124:127], v[224:227], a[88:91]
    ds_read_b128 a[168:171], v30 offset:45056
    v_accvgpr_read_b32 v60, a86
    v_mfma_f32_16x16x32_bf16 a[88:91], a[128:131], v[232:235], a[88:91]
    buffer_store_dword v49, v23, s[32:35], s9 offen sc1
    v_mfma_f32_16x16x32_bf16 a[88:91], a[132:135], v[240:243], a[88:91]
    ds_read_b128 a[172:175], v31 offset:45056
    v_accvgpr_read_b32 v61, a87
    v_mfma_f32_16x16x32_bf16 a[92:95], a[120:123], v[220:223], a[92:95]
    v_accvgpr_read_b32 v54, a80
    v_accvgpr_read_b32 v55, a81
    v_mfma_f32_16x16x32_bf16 a[92:95], a[124:127], v[228:231], a[92:95]
    ds_read_b128 a[176:179], v32 offset:45056
    v_accvgpr_read_b32 v56, a82
    v_mfma_f32_16x16x32_bf16 a[92:95], a[128:131], v[236:239], a[92:95]
    v_accvgpr_read_b32 v57, a83
    v_cvt_pk_bf16_f32 v54, v54, v58
    v_mfma_f32_16x16x32_bf16 a[92:95], a[132:135], v[244:247], a[92:95]
    s_waitcnt lgkmcnt(7)
    ds_read_b128 a[180:183], v33 offset:45056
    v_cvt_pk_bf16_f32 v55, v55, v59
    v_mfma_f32_16x16x32_bf16 a[92:95], a[136:139], v[92:95], a[92:95]
    s_nop 0
    v_cvt_pk_bf16_f32 v56, v56, v60
    v_cvt_pk_bf16_f32 v57, v57, v61
    v_mfma_f32_16x16x32_bf16 a[92:95], a[140:143], v[100:103], a[92:95]
    s_add_u32 s10, s47, 1146880
    ds_read_b128 a[120:123], v30 offset:49152
    v_mfma_f32_16x16x32_bf16 a[92:95], a[144:147], v[108:111], a[92:95]
    buffer_store_dword v54, v20, s[32:35], s10 offen sc1
    v_mfma_f32_16x16x32_bf16 a[92:95], a[148:151], v[116:119], a[92:95]
    ds_read_b128 a[124:127], v31 offset:49152
    v_mfma_f32_16x16x32_bf16 a[88:91], a[136:139], v[88:91], a[88:91]
    v_mfma_f32_16x16x32_bf16 a[88:91], a[140:143], v[96:99], a[88:91]
    ds_read_b128 a[128:131], v32 offset:49152
    v_mfma_f32_16x16x32_bf16 a[88:91], a[144:147], v[104:107], a[88:91]
    v_mfma_f32_16x16x32_bf16 a[88:91], a[148:151], v[112:115], a[88:91]
    s_waitcnt lgkmcnt(7)
    ds_read_b128 a[132:135], v33 offset:49152
    v_mfma_f32_16x16x32_bf16 a[88:91], a[152:155], v[120:123], a[88:91]
    s_nop 0
    v_mfma_f32_16x16x32_bf16 a[88:91], a[156:159], v[128:131], a[88:91]
    ds_read_b128 a[136:139], v30 offset:53248
    v_mfma_f32_16x16x32_bf16 a[88:91], a[160:163], v[136:139], a[88:91]
    buffer_store_dword v55, v21, s[32:35], s10 offen sc1
    v_mfma_f32_16x16x32_bf16 a[88:91], a[164:167], v[144:147], a[88:91]
    ds_read_b128 a[140:143], v31 offset:53248
    v_mfma_f32_16x16x32_bf16 a[92:95], a[152:155], v[124:127], a[92:95]
    v_mfma_f32_16x16x32_bf16 a[92:95], a[156:159], v[132:135], a[92:95]
    ds_read_b128 a[144:147], v32 offset:53248
    v_mfma_f32_16x16x32_bf16 a[92:95], a[160:163], v[140:143], a[92:95]
    v_mfma_f32_16x16x32_bf16 a[92:95], a[164:167], v[148:151], a[92:95]
    s_waitcnt lgkmcnt(7)
    ds_read_b128 a[148:151], v33 offset:53248
    v_mfma_f32_16x16x32_bf16 a[92:95], a[168:171], v[156:159], a[92:95]
    s_nop 0
    v_mfma_f32_16x16x32_bf16 a[92:95], a[172:175], v[164:167], a[92:95]
    ds_read_b128 a[152:155], v30 offset:57344
    v_mfma_f32_16x16x32_bf16 a[92:95], a[176:179], v[172:175], a[92:95]
    buffer_store_dword v56, v22, s[32:35], s10 offen sc1
    v_mfma_f32_16x16x32_bf16 a[92:95], a[180:183], v[180:183], a[92:95]
    ds_read_b128 a[156:159], v31 offset:57344
    v_mfma_f32_16x16x32_bf16 a[88:91], a[168:171], v[152:155], a[88:91]
    v_mfma_f32_16x16x32_bf16 a[88:91], a[172:175], v[160:163], a[88:91]
    ds_read_b128 a[160:163], v32 offset:57344
    v_mfma_f32_16x16x32_bf16 a[88:91], a[176:179], v[168:171], a[88:91]
    v_mfma_f32_16x16x32_bf16 a[88:91], a[180:183], v[176:179], a[88:91]
    s_waitcnt lgkmcnt(7)
    ds_read_b128 a[164:167], v33 offset:57344
    v_mfma_f32_16x16x32_bf16 a[96:99], a[120:123], v[216:219], a[96:99]
    s_nop 0
    v_accvgpr_read_b32 v66, a92
    v_accvgpr_read_b32 v67, a93
    v_mfma_f32_16x16x32_bf16 a[96:99], a[124:127], v[224:227], a[96:99]
    ds_read_b128 a[168:171], v30 offset:61440
    v_accvgpr_read_b32 v68, a94
    v_mfma_f32_16x16x32_bf16 a[96:99], a[128:131], v[232:235], a[96:99]
    buffer_store_dword v57, v23, s[32:35], s10 offen sc1
    v_mfma_f32_16x16x32_bf16 a[96:99], a[132:135], v[240:243], a[96:99]
    ds_read_b128 a[172:175], v31 offset:61440
    v_accvgpr_read_b32 v69, a95
    v_mfma_f32_16x16x32_bf16 a[100:103], a[120:123], v[220:223], a[100:103]
    v_accvgpr_read_b32 v62, a88
    v_accvgpr_read_b32 v63, a89
    v_mfma_f32_16x16x32_bf16 a[100:103], a[124:127], v[228:231], a[100:103]
    ds_read_b128 a[176:179], v32 offset:61440
    v_accvgpr_read_b32 v64, a90
    v_mfma_f32_16x16x32_bf16 a[100:103], a[128:131], v[236:239], a[100:103]
    v_accvgpr_read_b32 v65, a91
    v_cvt_pk_bf16_f32 v62, v62, v66
    v_mfma_f32_16x16x32_bf16 a[100:103], a[132:135], v[244:247], a[100:103]
    s_waitcnt lgkmcnt(7)
    ds_read_b128 a[180:183], v33 offset:61440
    v_cvt_pk_bf16_f32 v63, v63, v67
    v_mfma_f32_16x16x32_bf16 a[100:103], a[136:139], v[92:95], a[100:103]
    s_nop 0
    v_cvt_pk_bf16_f32 v64, v64, v68
    v_cvt_pk_bf16_f32 v65, v65, v69
    v_mfma_f32_16x16x32_bf16 a[100:103], a[140:143], v[100:103], a[100:103]
    s_add_u32 s11, s47, 1261568
    ds_read_b128 a[120:123], v34 offset:0
    v_mfma_f32_16x16x32_bf16 a[100:103], a[144:147], v[108:111], a[100:103]
    buffer_store_dword v62, v20, s[32:35], s11 offen sc1
    v_mfma_f32_16x16x32_bf16 a[100:103], a[148:151], v[116:119], a[100:103]
    ds_read_b128 a[124:127], v35 offset:0
    v_mfma_f32_16x16x32_bf16 a[96:99], a[136:139], v[88:91], a[96:99]
    v_mfma_f32_16x16x32_bf16 a[96:99], a[140:143], v[96:99], a[96:99]
    ds_read_b128 a[128:131], v36 offset:0
    v_mfma_f32_16x16x32_bf16 a[96:99], a[144:147], v[104:107], a[96:99]
    v_mfma_f32_16x16x32_bf16 a[96:99], a[148:151], v[112:115], a[96:99]
    s_waitcnt lgkmcnt(7)
    ds_read_b128 a[132:135], v37 offset:0
    v_mfma_f32_16x16x32_bf16 a[96:99], a[152:155], v[120:123], a[96:99]
    s_nop 0
    v_mfma_f32_16x16x32_bf16 a[96:99], a[156:159], v[128:131], a[96:99]
    ds_read_b128 a[136:139], v34 offset:4096
    v_mfma_f32_16x16x32_bf16 a[96:99], a[160:163], v[136:139], a[96:99]
    buffer_store_dword v63, v21, s[32:35], s11 offen sc1
    v_mfma_f32_16x16x32_bf16 a[96:99], a[164:167], v[144:147], a[96:99]
    ds_read_b128 a[140:143], v35 offset:4096
    v_mfma_f32_16x16x32_bf16 a[100:103], a[152:155], v[124:127], a[100:103]
    v_mfma_f32_16x16x32_bf16 a[100:103], a[156:159], v[132:135], a[100:103]
    ds_read_b128 a[144:147], v36 offset:4096
    v_mfma_f32_16x16x32_bf16 a[100:103], a[160:163], v[140:143], a[100:103]
    v_mfma_f32_16x16x32_bf16 a[100:103], a[164:167], v[148:151], a[100:103]
    s_waitcnt lgkmcnt(7)
    ds_read_b128 a[148:151], v37 offset:4096
    v_mfma_f32_16x16x32_bf16 a[100:103], a[168:171], v[156:159], a[100:103]
    s_nop 0
    v_mfma_f32_16x16x32_bf16 a[100:103], a[172:175], v[164:167], a[100:103]
    ds_read_b128 a[152:155], v34 offset:8192
    v_mfma_f32_16x16x32_bf16 a[100:103], a[176:179], v[172:175], a[100:103]
    buffer_store_dword v64, v22, s[32:35], s11 offen sc1
    v_mfma_f32_16x16x32_bf16 a[100:103], a[180:183], v[180:183], a[100:103]
    ds_read_b128 a[156:159], v35 offset:8192
    v_mfma_f32_16x16x32_bf16 a[96:99], a[168:171], v[152:155], a[96:99]
    v_mfma_f32_16x16x32_bf16 a[96:99], a[172:175], v[160:163], a[96:99]
    ds_read_b128 a[160:163], v36 offset:8192
    v_mfma_f32_16x16x32_bf16 a[96:99], a[176:179], v[168:171], a[96:99]
    v_mfma_f32_16x16x32_bf16 a[96:99], a[180:183], v[176:179], a[96:99]
    s_waitcnt lgkmcnt(7)
    ds_read_b128 a[164:167], v37 offset:8192
    v_mfma_f32_16x16x32_bf16 a[104:107], a[120:123], v[216:219], a[104:107]
    s_nop 0
    v_accvgpr_read_b32 v42, a100
    v_accvgpr_read_b32 v43, a101
    v_mfma_f32_16x16x32_bf16 a[104:107], a[124:127], v[224:227], a[104:107]
    ds_read_b128 a[168:171], v34 offset:12288
    v_accvgpr_read_b32 v44, a102
    v_mfma_f32_16x16x32_bf16 a[104:107], a[128:131], v[232:235], a[104:107]
    buffer_store_dword v65, v23, s[32:35], s11 offen sc1
    v_mfma_f32_16x16x32_bf16 a[104:107], a[132:135], v[240:243], a[104:107]
    ds_read_b128 a[172:175], v35 offset:12288
    v_accvgpr_read_b32 v45, a103
    v_mfma_f32_16x16x32_bf16 a[108:111], a[120:123], v[220:223], a[108:111]
    v_accvgpr_read_b32 v38, a96
    v_accvgpr_read_b32 v39, a97
    v_mfma_f32_16x16x32_bf16 a[108:111], a[124:127], v[228:231], a[108:111]
    ds_read_b128 a[176:179], v36 offset:12288
    v_accvgpr_read_b32 v40, a98
    v_mfma_f32_16x16x32_bf16 a[108:111], a[128:131], v[236:239], a[108:111]
    v_accvgpr_read_b32 v41, a99
    v_cvt_pk_bf16_f32 v38, v38, v42
    v_mfma_f32_16x16x32_bf16 a[108:111], a[132:135], v[244:247], a[108:111]
    s_waitcnt lgkmcnt(7)
    ds_read_b128 a[180:183], v37 offset:12288
    v_cvt_pk_bf16_f32 v39, v39, v43
    v_mfma_f32_16x16x32_bf16 a[108:111], a[136:139], v[92:95], a[108:111]
    s_nop 0
    v_cvt_pk_bf16_f32 v40, v40, v44
    v_cvt_pk_bf16_f32 v41, v41, v45
    v_mfma_f32_16x16x32_bf16 a[108:111], a[140:143], v[100:103], a[108:111]
    s_add_u32 s8, s47, 1376256
    ds_read_b128 a[120:123], v34 offset:16384
    v_mfma_f32_16x16x32_bf16 a[108:111], a[144:147], v[108:111], a[108:111]
    buffer_store_dword v38, v20, s[32:35], s8 offen sc1
    v_mfma_f32_16x16x32_bf16 a[108:111], a[148:151], v[116:119], a[108:111]
    ds_read_b128 a[124:127], v35 offset:16384
    v_mfma_f32_16x16x32_bf16 a[104:107], a[136:139], v[88:91], a[104:107]
    v_mfma_f32_16x16x32_bf16 a[104:107], a[140:143], v[96:99], a[104:107]
    ds_read_b128 a[128:131], v36 offset:16384
    v_mfma_f32_16x16x32_bf16 a[104:107], a[144:147], v[104:107], a[104:107]
    v_mfma_f32_16x16x32_bf16 a[104:107], a[148:151], v[112:115], a[104:107]
    s_waitcnt lgkmcnt(7)
    ds_read_b128 a[132:135], v37 offset:16384
    v_mfma_f32_16x16x32_bf16 a[104:107], a[152:155], v[120:123], a[104:107]
    s_nop 0
    v_mfma_f32_16x16x32_bf16 a[104:107], a[156:159], v[128:131], a[104:107]
    ds_read_b128 a[136:139], v34 offset:20480
    v_mfma_f32_16x16x32_bf16 a[104:107], a[160:163], v[136:139], a[104:107]
    buffer_store_dword v39, v21, s[32:35], s8 offen sc1
    v_mfma_f32_16x16x32_bf16 a[104:107], a[164:167], v[144:147], a[104:107]
    ds_read_b128 a[140:143], v35 offset:20480
    v_mfma_f32_16x16x32_bf16 a[108:111], a[152:155], v[124:127], a[108:111]
    v_mfma_f32_16x16x32_bf16 a[108:111], a[156:159], v[132:135], a[108:111]
    ds_read_b128 a[144:147], v36 offset:20480
    v_mfma_f32_16x16x32_bf16 a[108:111], a[160:163], v[140:143], a[108:111]
    v_mfma_f32_16x16x32_bf16 a[108:111], a[164:167], v[148:151], a[108:111]
    s_waitcnt lgkmcnt(7)
    ds_read_b128 a[148:151], v37 offset:20480
    v_mfma_f32_16x16x32_bf16 a[108:111], a[168:171], v[156:159], a[108:111]
    s_nop 0
    v_mfma_f32_16x16x32_bf16 a[108:111], a[172:175], v[164:167], a[108:111]
    ds_read_b128 a[152:155], v34 offset:24576
    v_mfma_f32_16x16x32_bf16 a[108:111], a[176:179], v[172:175], a[108:111]
    buffer_store_dword v40, v22, s[32:35], s8 offen sc1
    v_mfma_f32_16x16x32_bf16 a[108:111], a[180:183], v[180:183], a[108:111]
    ds_read_b128 a[156:159], v35 offset:24576
    v_mfma_f32_16x16x32_bf16 a[104:107], a[168:171], v[152:155], a[104:107]
    v_mfma_f32_16x16x32_bf16 a[104:107], a[172:175], v[160:163], a[104:107]
    ds_read_b128 a[160:163], v36 offset:24576
    v_mfma_f32_16x16x32_bf16 a[104:107], a[176:179], v[168:171], a[104:107]
L_padA5:
    s_cbranch_vccnz L_backA
    s_nop 0
    v_mfma_f32_16x16x32_bf16 a[104:107], a[180:183], v[176:179], a[104:107]
    s_waitcnt lgkmcnt(7)
    ds_read_b128 a[164:167], v37 offset:24576
    v_mfma_f32_16x16x32_bf16 v[248:251], a[120:123], v[216:219], v[248:251]
    s_nop 0
    v_accvgpr_read_b32 v50, a108
    v_accvgpr_read_b32 v51, a109
    v_mfma_f32_16x16x32_bf16 v[248:251], a[124:127], v[224:227], v[248:251]
    ds_read_b128 a[168:171], v34 offset:28672
    v_accvgpr_read_b32 v52, a110
    v_mfma_f32_16x16x32_bf16 v[248:251], a[128:131], v[232:235], v[248:251]
    buffer_store_dword v41, v23, s[32:35], s8 offen sc1
    v_mfma_f32_16x16x32_bf16 v[248:251], a[132:135], v[240:243], v[248:251]
    ds_read_b128 a[172:175], v35 offset:28672
    v_accvgpr_read_b32 v53, a111
    v_mfma_f32_16x16x32_bf16 v[252:255], a[120:123], v[220:223], v[252:255]
    v_accvgpr_read_b32 v46, a104
    v_accvgpr_read_b32 v47, a105
    v_mfma_f32_16x16x32_bf16 v[252:255], a[124:127], v[228:231], v[252:255]
    ds_read_b128 a[176:179], v36 offset:28672
    v_accvgpr_read_b32 v48, a106
    v_mfma_f32_16x16x32_bf16 v[252:255], a[128:131], v[236:239], v[252:255]
    v_accvgpr_read_b32 v49, a107
    v_cvt_pk_bf16_f32 v46, v46, v50
    v_mfma_f32_16x16x32_bf16 v[252:255], a[132:135], v[244:247], v[252:255]
    s_waitcnt lgkmcnt(7)
    ds_read_b128 a[180:183], v37 offset:28672
    v_cvt_pk_bf16_f32 v47, v47, v51
    v_mfma_f32_16x16x32_bf16 v[252:255], a[136:139], v[92:95], v[252:255]
    s_nop 0
    v_cvt_pk_bf16_f32 v48, v48, v52
    v_cvt_pk_bf16_f32 v49, v49, v53
    v_mfma_f32_16x16x32_bf16 v[252:255], a[140:143], v[100:103], v[252:255]
    s_add_u32 s9, s47, 1490944
    v_mfma_f32_16x16x32_bf16 v[252:255], a[144:147], v[108:111], v[252:255]
    buffer_store_dword v46, v20, s[32:35], s9 offen sc1
    v_mfma_f32_16x16x32_bf16 v[252:255], a[148:151], v[116:119], v[252:255]
    v_mfma_f32_16x16x32_bf16 v[248:251], a[136:139], v[88:91], v[248:251]
    buffer_store_dword v47, v21, s[32:35], s9 offen sc1
    v_mfma_f32_16x16x32_bf16 v[248:251], a[140:143], v[96:99], v[248:251]
    v_mfma_f32_16x16x32_bf16 v[248:251], a[144:147], v[104:107], v[248:251]
    buffer_store_dword v48, v22, s[32:35], s9 offen sc1
    v_mfma_f32_16x16x32_bf16 v[248:251], a[148:151], v[112:115], v[248:251]
    s_waitcnt lgkmcnt(4)
    v_mfma_f32_16x16x32_bf16 v[248:251], a[152:155], v[120:123], v[248:251]
    buffer_store_dword v49, v23, s[32:35], s9 offen sc1
    v_mfma_f32_16x16x32_bf16 v[248:251], a[156:159], v[128:131], v[248:251]
    s_nop 0
    v_mfma_f32_16x16x32_bf16 v[248:251], a[160:163], v[136:139], v[248:251]
    v_mfma_f32_16x16x32_bf16 v[248:251], a[164:167], v[144:147], v[248:251]
    v_mfma_f32_16x16x32_bf16 v[252:255], a[152:155], v[124:127], v[252:255]
    v_mfma_f32_16x16x32_bf16 v[252:255], a[156:159], v[132:135], v[252:255]
    v_mfma_f32_16x16x32_bf16 v[252:255], a[160:163], v[140:143], v[252:255]
    v_mfma_f32_16x16x32_bf16 v[252:255], a[164:167], v[148:151], v[252:255]
    s_waitcnt lgkmcnt(0)
    v_mfma_f32_16x16x32_bf16 v[252:255], a[168:171], v[156:159], v[252:255]
    s_nop 0
    v_mfma_f32_16x16x32_bf16 v[252:255], a[172:175], v[164:167], v[252:255]
    v_mfma_f32_16x16x32_bf16 v[252:255], a[176:179], v[172:175], v[252:255]
    v_mfma_f32_16x16x32_bf16 v[252:255], a[180:183], v[180:183], v[252:255]
    v_mfma_f32_16x16x32_bf16 v[248:251], a[168:171], v[152:155], v[248:251]
    v_mfma_f32_16x16x32_bf16 v[248:251], a[172:175], v[160:163], v[248:251]
    v_mfma_f32_16x16x32_bf16 v[248:251], a[176:179], v[168:171], v[248:251]
    s_add_u32 s10, s47, 1605632
    v_mfma_f32_16x16x32_bf16 v[248:251], a[180:183], v[176:179], v[248:251]
    s_nop 7
    v_cvt_pk_bf16_f32 v54, v248, v252
    v_cvt_pk_bf16_f32 v55, v249, v253
    v_cvt_pk_bf16_f32 v56, v250, v254
    v_cvt_pk_bf16_f32 v57, v251, v255
    buffer_store_dword v54, v20, s[32:35], s10 offen sc1
    buffer_store_dword v55, v21, s[32:35], s10 offen sc1
    buffer_store_dword v56, v22, s[32:35], s10 offen sc1
    buffer_store_dword v57, v23, s[32:35], s10 offen sc1
    s_endpgm
L_B:
    s_mov_b64 vcc, -1
    s_cmp_eq_u32 s44, 0
    s_cbranch_scc1 L_padB0
    s_cmp_eq_u32 s44, 64
    s_cbranch_scc1 L_padB1
    s_cmp_eq_u32 s44, 128
    s_cbranch_scc1 L_padB2
    s_cmp_eq_u32 s44, 192
    s_cbranch_scc1 L_backB
L_backB:
    s_mov_b64 vcc, 0
    s_waitcnt vmcnt(9)
    s_add_u32 m0, s45, 16384
    s_nop 0
    buffer_load_dwordx4 v5, s[16:19], 0 offen offset:0 lds
    s_add_u32 m0, s45, 20480
    s_nop 0
    buffer_load_dwordx4 v6, s[16:19], 0 offen offset:0 lds
    s_add_u32 m0, s45, 24576
    s_nop 0
    buffer_load_dwordx4 v7, s[16:19], 0 offen offset:0 lds
    s_add_u32 m0, s45, 28672
    s_nop 0
    buffer_load_dwordx4 v8, s[16:19], 0 offen offset:0 lds
    s_sub_u32 s8, s65, s44
    v_and_b32 v240, 63, v0
    v_min_u32 v241, 23, v240
    v_lshrrev_b32 v242, 1, v241
    v_and_b32 v241, 1, v241
    v_mul_u32_u24 v242, 7168, v242
    v_lshl_add_u32 v241, v241, 7, v242
    s_cmp_eq_u32 s44, 0
    s_cbranch_scc1 L_bpf0
    buffer_load_dword v24, v241, s[28:31], s8 offen
    s_branch L_bpf1
L_bpf0:
    buffer_load_dword v24, v241, s[24:27], s8 offen
L_bpf1:
    s_lshl_b32 s9, s44, 1
    s_sub_u32 s8, s58, s9
    s_mul_i32 s9, s44, 224
    v_min_u32 v241, 47, v240
    s_add_u32 s8, s8, s9
    v_lshrrev_b32 v242, 2, v241
    v_and_b32 v241, 3, v241
    v_mul_u32_u24 v242, 57344, v242
    v_lshl_add_u32 v241, v241, 7, v242
    buffer_load_dword v24, v241, s[20:23], s8 offen
    v_lshlrev_b32 v84, 16, v50
    v_lshlrev_b32 v85, 16, v51
    v_mul_f32 v80, v85, v84
    v_sub_f32 v81, v84, v80
    v_fma_f32 v82, 2.0, v84, -v80
    v_fma_f32 v83, s41, v84, -v80
    v_cvt_pk_bf16_f32 v80, -v80, v81
    v_cvt_pk_bf16_f32 v82, v82, v83
    v_perm_b32 v54, v82, v80, s42
    v_perm_b32 v58, v82, v80, s42
    v_perm_b32 v55, v82, v80, s43
    v_perm_b32 v59, v82, v80, s43
    v_and_b32 v84, 0xffff0000, v50
    v_and_b32 v85, 0xffff0000, v51
    v_mul_f32 v80, v85, v84
    v_sub_f32 v81, v84, v80
    v_fma_f32 v82, 2.0, v84, -v80
    v_fma_f32 v83, s41, v84, -v80
    v_cvt_pk_bf16_f32 v80, -v80, v81
    v_cvt_pk_bf16_f32 v82, v82, v83
    v_perm_b32 v56, v82, v80, s42
    v_perm_b32 v60, v82, v80, s42
    v_perm_b32 v57, v82, v80, s43
    v_perm_b32 v61, v82, v80, s43
    v_permlane16_swap_b32 v54, v58
    v_permlane16_swap_b32 v55, v59
    v_permlane16_swap_b32 v56, v60
    v_permlane16_swap_b32 v57, v61
    s_waitcnt vmcnt(14)
    v_lshrrev_b64 v[70:71], 2, v[38:39]
    v_perm_b32 v72, v70, v38, s36
    v_perm_b32 v73, v70, v38, s37
    v_and_or_b32 v88, v72, s40, v19
    v_lshrrev_b64 v[74:75], 4, v[72:73]
    v_and_or_b32 v90, v73, s40, v19
    v_perm_b32 v88, v55, v54, v88
    v_and_or_b32 v89, v74, s40, v19
    v_perm_b32 v90, v55, v54, v90
    v_and_or_b32 v91, v75, s40, v19
    v_perm_b32 v89, v55, v54, v89
    v_perm_b32 v91, v55, v54, v91
    v_perm_b32 v76, v71, v39, s36
    v_perm_b32 v77, v71, v39, s37
    v_and_or_b32 v92, v76, s40, v19
    v_lshrrev_b64 v[78:79], 4, v[76:77]
    v_and_or_b32 v94, v77, s40, v19
    v_perm_b32 v92, v57, v56, v92
    v_and_or_b32 v93, v78, s40, v19
    v_perm_b32 v94, v57, v56, v94
    v_and_or_b32 v95, v79, s40, v19
    v_perm_b32 v93, v57, v56, v93
    v_perm_b32 v95, v57, v56, v95
    v_perm_b32 v72, v70, v38, s38
    v_perm_b32 v73, v70, v38, s39
    v_and_or_b32 v96, v72, s40, v19
    v_lshrrev_b64 v[74:75], 4, v[72:73]
    v_and_or_b32 v98, v73, s40, v19
    v_perm_b32 v96, v55, v54, v96
    v_and_or_b32 v97, v74, s40, v19
    v_perm_b32 v98, v55, v54, v98
    v_and_or_b32 v99, v75, s40, v19
    v_perm_b32 v97, v55, v54, v97
    v_perm_b32 v99, v55, v54, v99
    v_perm_b32 v76, v71, v39, s38
    v_perm_b32 v77, v71, v39, s39
    v_and_or_b32 v100, v76, s40, v19
    v_lshrrev_b64 v[78:79], 4, v[76:77]
    v_and_or_b32 v102, v77, s40, v19
    v_perm_b32 v100, v57, v56, v100
    v_and_or_b32 v101, v78, s40, v19
    v_perm_b32 v102, v57, v56, v102
    v_and_or_b32 v103, v79, s40, v19
    v_perm_b32 v101, v57, v56, v101
    v_perm_b32 v103, v57, v56, v103
    s_waitcnt vmcnt(13)
    v_lshrrev_b64 v[70:71], 2, v[40:41]
    v_perm_b32 v72, v70, v40, s36
    v_perm_b32 v73, v70, v40, s37
    v_and_or_b32 v104, v72, s40, v19
    v_lshrrev_b64 v[74:75], 4, v[72:73]
    v_and_or_b32 v106, v73, s40, v19
    v_perm_b32 v104, v55, v54, v104
    v_and_or_b32 v105, v74, s40, v19
    v_perm_b32 v106, v55, v54, v106
    v_and_or_b32 v107, v75, s40, v19
    v_perm_b32 v105, v55, v54, v105
    v_perm_b32 v107, v55, v54, v107
    v_perm_b32 v76, v71, v41, s36
    v_perm_b32 v77, v71, v41, s37
    v_and_or_b32 v108, v76, s40, v19
    v_lshrrev_b64 v[78:79], 4, v[76:77]
    v_and_or_b32 v110, v77, s40, v19
    v_perm_b32 v108, v57, v56, v108
    v_and_or_b32 v109, v78, s40, v19
    v_perm_b32 v110, v57, v56, v110
    v_and_or_b32 v111, v79, s40, v19
    v_perm_b32 v109, v57, v56, v109
    v_perm_b32 v111, v57, v56, v111
    v_perm_b32 v72, v70, v40, s38
    v_perm_b32 v73, v70, v40, s39
    v_and_or_b32 v112, v72, s40, v19
    v_lshrrev_b64 v[74:75], 4, v[72:73]
    v_and_or_b32 v114, v73, s40, v19
    v_perm_b32 v112, v55, v54, v112
    v_and_or_b32 v113, v74, s40, v19
    v_perm_b32 v114, v55, v54, v114
    v_and_or_b32 v115, v75, s40, v19
    v_perm_b32 v113, v55, v54, v113
    v_perm_b32 v115, v55, v54, v115
    v_perm_b32 v76, v71, v41, s38
    v_perm_b32 v77, v71, v41, s39
    v_and_or_b32 v116, v76, s40, v19
    v_lshrrev_b64 v[78:79], 4, v[76:77]
    v_and_or_b32 v118, v77, s40, v19
    v_perm_b32 v116, v57, v56, v116
    v_and_or_b32 v117, v78, s40, v19
    v_perm_b32 v118, v57, v56, v118
    v_and_or_b32 v119, v79, s40, v19
    v_perm_b32 v117, v57, v56, v117
    v_perm_b32 v119, v57, v56, v119
    s_add_u32 m0, s45, 32512
    s_nop 0
    buffer_load_dwordx4 v1, s[16:19], 0 offen offset:256 lds
    s_add_u32 m0, s45, 36608
    s_nop 0
    buffer_load_dwordx4 v2, s[16:19], 0 offen offset:256 lds
    s_add_u32 m0, s45, 40704
    s_nop 0
    buffer_load_dwordx4 v3, s[16:19], 0 offen offset:256 lds
    s_add_u32 m0, s45, 44800
    s_nop 0
    buffer_load_dwordx4 v4, s[16:19], 0 offen offset:256 lds
    s_waitcnt vmcnt(13)
    s_barrier
    ds_read_b128 a[120:123], v26 offset:0
    ds_read_b128 a[124:127], v27 offset:0
    ds_read_b128 a[128:131], v28 offset:0
    ds_read_b128 a[132:135], v29 offset:0
    ds_read_b128 a[136:139], v26 offset:4096
    ds_read_b128 a[140:143], v27 offset:4096
    ds_read_b128 a[144:147], v28 offset:4096
    ds_read_b128 a[148:151], v29 offset:4096
    s_waitcnt lgkmcnt(7)
.p2align 3
    v_mfma_f32_16x16x32_bf16 a[0:3], a[120:123], v[88:91], 0
    s_waitcnt lgkmcnt(6)
    v_mfma_f32_16x16x32_bf16 a[0:3], a[124:127], v[96:99], a[0:3]
    s_waitcnt lgkmcnt(5)
    s_add_u32 m0, s45, 48896
    v_mfma_f32_16x16x32_bf16 a[0:3], a[128:131], v[104:107], a[0:3]
    s_waitcnt lgkmcnt(4)
    buffer_load_dwordx4 v5, s[16:19], 0 offen offset:256 lds
    v_mfma_f32_16x16x32_bf16 a[0:3], a[132:135], v[112:115], a[0:3]
    s_mov_b64 s[24:25], s[80:81]
    v_mfma_f32_16x16x32_bf16 a[4:7], a[120:123], v[92:95], 0
    buffer_load_dword v52, v18, s[24:27], 0 offen
    v_mfma_f32_16x16x32_bf16 a[4:7], a[124:127], v[100:103], a[4:7]
    v_mfma_f32_16x16x32_bf16 a[4:7], a[128:131], v[108:111], a[4:7]
    s_add_u32 m0, s45, 52992
    v_mfma_f32_16x16x32_bf16 a[4:7], a[132:135], v[116:119], a[4:7]
    s_waitcnt vmcnt(13) lgkmcnt(0)
    v_mfma_f32_16x16x32_bf16 a[8:11], a[136:139], v[88:91], 0
    buffer_load_dwordx4 v6, s[16:19], 0 offen offset:256 lds
    v_mfma_f32_16x16x32_bf16 a[8:11], a[140:143], v[96:99], a[8:11]
    s_mov_b64 s[28:29], s[82:83]
    v_lshrrev_b64 v[70:71], 2, v[42:43]
    v_perm_b32 v72, v70, v42, s36
    v_perm_b32 v73, v70, v42, s37
    v_and_or_b32 v120, v72, s40, v19
    v_lshrrev_b64 v[74:75], 4, v[72:73]
    v_mfma_f32_16x16x32_bf16 a[8:11], a[144:147], v[104:107], a[8:11]
    buffer_load_dword v53, v18, s[28:31], 0 offen
    v_and_or_b32 v122, v73, s40, v19
    v_mfma_f32_16x16x32_bf16 a[8:11], a[148:151], v[112:115], a[8:11]
    s_mov_b64 s[20:21], s[68:69]
    v_perm_b32 v120, v59, v58, v120
    v_and_or_b32 v121, v74, s40, v19
    v_mfma_f32_16x16x32_bf16 a[12:15], a[136:139], v[92:95], 0
    buffer_load_dwordx2 v[46:47], v16, s[20:23], 0 offen
    v_perm_b32 v122, v59, v58, v122
    v_mfma_f32_16x16x32_bf16 a[12:15], a[140:143], v[100:103], a[12:15]
    s_addk_i32 m0, 4096
    v_and_or_b32 v123, v75, s40, v19
    v_perm_b32 v121, v59, v58, v121
    v_perm_b32 v123, v59, v58, v123
    v_mfma_f32_16x16x32_bf16 a[12:15], a[144:147], v[108:111], a[12:15]
    buffer_load_dwordx4 v7, s[16:19], 0 offen offset:256 lds
    v_perm_b32 v76, v71, v43, s36
    v_mfma_f32_16x16x32_bf16 a[12:15], a[148:151], v[116:119], a[12:15]
    s_mov_b64 s[24:25], s[84:85]
    ds_read_b128 a[152:155], v26 offset:8192
    ds_read_b128 a[156:159], v27 offset:8192
    ds_read_b128 a[160:163], v28 offset:8192
    ds_read_b128 a[164:167], v29 offset:8192
    ds_read_b128 a[168:171], v26 offset:12288
    ds_read_b128 a[172:175], v27 offset:12288
    ds_read_b128 a[176:179], v28 offset:12288
    ds_read_b128 a[180:183], v29 offset:12288
    s_waitcnt lgkmcnt(0)
    v_mfma_f32_16x16x32_bf16 a[16:19], a[152:155], v[88:91], 0
    buffer_load_dword v50, v18, s[24:27], 0 offen
    v_perm_b32 v77, v71, v43, s37
    v_mfma_f32_16x16x32_bf16 a[16:19], a[156:159], v[96:99], a[16:19]
    v_and_or_b32 v124, v76, s40, v19
    v_lshrrev_b64 v[78:79], 4, v[76:77]
    v_mfma_f32_16x16x32_bf16 a[16:19], a[160:163], v[104:107], a[16:19]
    buffer_load_dwordx2 v[48:49], v17, s[20:23], 0 offen
    v_and_or_b32 v126, v77, s40, v19
    v_mfma_f32_16x16x32_bf16 a[16:19], a[164:167], v[112:115], a[16:19]
    s_add_u32 m0, s45, 61184
    v_perm_b32 v124, v61, v60, v124
    v_and_or_b32 v125, v78, s40, v19
    v_perm_b32 v126, v61, v60, v126
    v_mfma_f32_16x16x32_bf16 a[20:23], a[152:155], v[92:95], 0
    buffer_load_dwordx4 v8, s[16:19], 0 offen offset:256 lds
    v_and_or_b32 v127, v79, s40, v19
    v_mfma_f32_16x16x32_bf16 a[20:23], a[156:159], v[100:103], a[20:23]
    s_mov_b64 s[28:29], s[86:87]
    v_perm_b32 v125, v61, v60, v125
    v_perm_b32 v127, v61, v60, v127
    v_mfma_f32_16x16x32_bf16 a[20:23], a[160:163], v[108:111], a[20:23]
    buffer_load_dword v51, v18, s[28:31], 0 offen
    v_perm_b32 v72, v70, v42, s38
    v_mfma_f32_16x16x32_bf16 a[20:23], a[164:167], v[116:119], a[20:23]
    s_waitcnt vmcnt(16)
    v_perm_b32 v73, v70, v42, s39
    v_and_or_b32 v128, v72, s40, v19
    v_lshrrev_b64 v[74:75], 4, v[72:73]
    v_mfma_f32_16x16x32_bf16 a[24:27], a[168:171], v[88:91], 0
    s_barrier
    v_mfma_f32_16x16x32_bf16 a[24:27], a[172:175], v[96:99], a[24:27]
    s_addk_i32 m0, 3840
    v_and_or_b32 v130, v73, s40, v19
    v_perm_b32 v128, v59, v58, v128
    v_mfma_f32_16x16x32_bf16 a[24:27], a[176:179], v[104:107], a[24:27]
    buffer_load_dwordx4 v1, s[16:19], 0 offen offset:512 lds
    v_and_or_b32 v129, v74, s40, v19
    v_mfma_f32_16x16x32_bf16 a[24:27], a[180:183], v[112:115], a[24:27]
    v_perm_b32 v130, v59, v58, v130
    v_and_or_b32 v131, v75, s40, v19
    v_mfma_f32_16x16x32_bf16 a[28:31], a[168:171], v[92:95], 0
    v_perm_b32 v129, v59, v58, v129
    v_perm_b32 v131, v59, v58, v131
    v_perm_b32 v76, v71, v43, s38
    v_mfma_f32_16x16x32_bf16 a[28:31], a[172:175], v[100:103], a[28:31]
    v_perm_b32 v77, v71, v43, s39
    v_and_or_b32 v132, v76, s40, v19
    v_mfma_f32_16x16x32_bf16 a[28:31], a[176:179], v[108:111], a[28:31]
    v_lshrrev_b64 v[78:79], 4, v[76:77]
    v_and_or_b32 v134, v77, s40, v19
    v_mfma_f32_16x16x32_bf16 a[28:31], a[180:183], v[116:119], a[28:31]
    s_add_u32 m0, s45, 69120
    ds_read_b128 a[120:123], v26 offset:16384
    ds_read_b128 a[124:127], v27 offset:16384
    ds_read_b128 a[128:131], v28 offset:16384
    ds_read_b128 a[132:135], v29 offset:16384
    ds_read_b128 a[136:139], v26 offset:20480
    ds_read_b128 a[140:143], v27 offset:20480
    ds_read_b128 a[144:147], v28 offset:20480
    ds_read_b128 a[148:151], v29 offset:20480
    s_waitcnt lgkmcnt(0)
    v_mfma_f32_16x16x32_bf16 a[32:35], a[120:123], v[88:91], 0
    buffer_load_dwordx4 v2, s[16:19], 0 offen offset:512 lds
    v_perm_b32 v132, v61, v60, v132
    v_and_or_b32 v133, v78, s40, v19
    v_mfma_f32_16x16x32_bf16 a[32:35], a[124:127], v[96:99], a[32:35]
    s_nop 0
    v_perm_b32 v134, v61, v60, v134
    v_and_or_b32 v135, v79, s40, v19
    v_mfma_f32_16x16x32_bf16 a[32:35], a[128:131], v[104:107], a[32:35]
    v_perm_b32 v133, v61, v60, v133
    v_perm_b32 v135, v61, v60, v135
    v_mfma_f32_16x16x32_bf16 a[32:35], a[132:135], v[112:115], a[32:35]
    v_lshrrev_b64 v[70:71], 2, v[44:45]
    v_perm_b32 v72, v70, v44, s36
    v_mfma_f32_16x16x32_bf16 a[36:39], a[120:123], v[92:95], 0
    v_perm_b32 v73, v70, v44, s37
    v_and_or_b32 v136, v72, s40, v19
    v_lshrrev_b64 v[74:75], 4, v[72:73]
    v_mfma_f32_16x16x32_bf16 a[36:39], a[124:127], v[100:103], a[36:39]
    s_add_u32 m0, s45, 73216
    v_and_or_b32 v138, v73, s40, v19
    v_perm_b32 v136, v59, v58, v136
    v_mfma_f32_16x16x32_bf16 a[36:39], a[128:131], v[108:111], a[36:39]
    buffer_load_dwordx4 v3, s[16:19], 0 offen offset:512 lds
    v_and_or_b32 v137, v74, s40, v19
    v_mfma_f32_16x16x32_bf16 a[36:39], a[132:135], v[116:119], a[36:39]
    v_perm_b32 v138, v59, v58, v138
    v_and_or_b32 v139, v75, s40, v19
    v_mfma_f32_16x16x32_bf16 a[40:43], a[136:139], v[88:91], 0
    v_perm_b32 v137, v59, v58, v137
    v_perm_b32 v139, v59, v58, v139
    v_perm_b32 v76, v71, v45, s36
    v_mfma_f32_16x16x32_bf16 a[40:43], a[140:143], v[96:99], a[40:43]
    v_perm_b32 v77, v71, v45, s37
    v_and_or_b32 v140, v76, s40, v19
    v_mfma_f32_16x16x32_bf16 a[40:43], a[144:147], v[104:107], a[40:43]
    v_lshrrev_b64 v[78:79], 4, v[76:77]
    v_and_or_b32 v142, v77, s40, v19
    v_mfma_f32_16x16x32_bf16 a[40:43], a[148:151], v[112:115], a[40:43]
    s_add_u32 m0, s45, 77312
    v_perm_b32 v140, v61, v60, v140
    v_and_or_b32 v141, v78, s40, v19
    v_perm_b32 v142, v61, v60, v142
    v_mfma_f32_16x16x32_bf16 a[44:47], a[136:139], v[92:95], 0
    buffer_load_dwordx4 v4, s[16:19], 0 offen offset:512 lds
    v_and_or_b32 v143, v79, s40, v19
    v_mfma_f32_16x16x32_bf16 a[44:47], a[140:143], v[100:103], a[44:47]
    v_perm_b32 v141, v61, v60, v141
    v_perm_b32 v143, v61, v60, v143
    v_mfma_f32_16x16x32_bf16 a[44:47], a[144:147], v[108:111], a[44:47]
    v_perm_b32 v72, v70, v44, s38
    v_perm_b32 v73, v70, v44, s39
    v_mfma_f32_16x16x32_bf16 a[44:47], a[148:151], v[116:119], a[44:47]
    ds_read_b128 a[152:155], v26 offset:24576
    ds_read_b128 a[156:159], v27 offset:24576
    ds_read_b128 a[160:163], v28 offset:24576
    ds_read_b128 a[164:167], v29 offset:24576
    ds_read_b128 a[168:171], v26 offset:28672
    ds_read_b128 a[172:175], v27 offset:28672
    ds_read_b128 a[176:179], v28 offset:28672
    ds_read_b128 a[180:183], v29 offset:28672
    s_waitcnt lgkmcnt(0)
    v_mfma_f32_16x16x32_bf16 a[48:51], a[152:155], v[88:91], 0
    s_nop 0
    v_and_or_b32 v144, v72, s40, v19
    v_lshrrev_b64 v[74:75], 4, v[72:73]
    v_and_or_b32 v146, v73, s40, v19
    v_mfma_f32_16x16x32_bf16 a[48:51], a[156:159], v[96:99], a[48:51]
    s_add_u32 m0, s45, 81408
    v_perm_b32 v144, v59, v58, v144
    v_and_or_b32 v145, v74, s40, v19
    v_mfma_f32_16x16x32_bf16 a[48:51], a[160:163], v[104:107], a[48:51]
    buffer_load_dwordx4 v5, s[16:19], 0 offen offset:512 lds
    v_perm_b32 v146, v59, v58, v146
    v_mfma_f32_16x16x32_bf16 a[48:51], a[164:167], v[112:115], a[48:51]
    s_mov_b64 s[20:21], s[70:71]
    v_and_or_b32 v147, v75, s40, v19
    v_perm_b32 v145, v59, v58, v145
    v_mfma_f32_16x16x32_bf16 a[52:55], a[152:155], v[92:95], 0
    buffer_load_dwordx2 v[38:39], v16, s[20:23], 0 offen
    v_perm_b32 v147, v59, v58, v147
    v_perm_b32 v76, v71, v45, s38
    v_mfma_f32_16x16x32_bf16 a[52:55], a[156:159], v[100:103], a[52:55]
    s_nop 0
    v_perm_b32 v77, v71, v45, s39
    v_and_or_b32 v148, v76, s40, v19
    v_mfma_f32_16x16x32_bf16 a[52:55], a[160:163], v[108:111], a[52:55]
    v_lshrrev_b64 v[78:79], 4, v[76:77]
    v_and_or_b32 v150, v77, s40, v19
    v_mfma_f32_16x16x32_bf16 a[52:55], a[164:167], v[116:119], a[52:55]
    s_waitcnt vmcnt(16)
    v_perm_b32 v148, v61, v60, v148
    v_and_or_b32 v149, v78, s40, v19
    v_perm_b32 v150, v61, v60, v150
    v_mfma_f32_16x16x32_bf16 v[248:251], a[168:171], v[88:91], 0
    s_barrier
    v_mfma_f32_16x16x32_bf16 v[248:251], a[172:175], v[96:99], v[248:251]
    s_add_u32 m0, s45, 85504
    v_and_or_b32 v151, v79, s40, v19
    v_perm_b32 v149, v61, v60, v149
    v_mfma_f32_16x16x32_bf16 v[248:251], a[176:179], v[104:107], v[248:251]
    buffer_load_dwordx4 v6, s[16:19], 0 offen offset:512 lds
    v_perm_b32 v151, v61, v60, v151
    v_mfma_f32_16x16x32_bf16 v[248:251], a[180:183], v[112:115], v[248:251]
    s_waitcnt vmcnt(13)
    v_lshlrev_b32 v84, 16, v52
    v_lshlrev_b32_e64 v85, 16, v53
    v_mfma_f32_16x16x32_bf16 v[252:255], a[168:171], v[92:95], 0
    buffer_load_dword v24, v25, s[16:19], 0 offen offset:1024
    v_mul_f32_e64 v80, v85, v84
    v_mfma_f32_16x16x32_bf16 v[252:255], a[172:175], v[100:103], v[252:255]
    s_add_u32 m0, s45, 89600
    v_sub_f32_e64 v81, v84, v80
    v_fma_f32 v82, 2.0, v84, -v80
    v_fma_f32 v83, s41, v84, -v80
    v_mfma_f32_16x16x32_bf16 v[252:255], a[176:179], v[108:111], v[252:255]
    buffer_load_dwordx4 v7, s[16:19], 0 offen offset:512 lds
    v_cvt_pk_bf16_f32 v80, -v80, v81
    v_mfma_f32_16x16x32_bf16 v[252:255], a[180:183], v[116:119], v[252:255]
    ds_read_b128 a[120:123], v26 offset:32768
    ds_read_b128 a[124:127], v27 offset:32768
    ds_read_b128 a[128:131], v28 offset:32768
    ds_read_b128 a[132:135], v29 offset:32768
    ds_read_b128 a[136:139], v26 offset:36864
    ds_read_b128 a[140:143], v27 offset:36864
    ds_read_b128 a[144:147], v28 offset:36864
    ds_read_b128 a[148:151], v29 offset:36864
    s_waitcnt lgkmcnt(0)
    v_mfma_f32_16x16x32_bf16 a[0:3], a[120:123], v[120:123], a[0:3]
    s_nop 0
    v_cvt_pk_bf16_f32 v82, v82, v83
    v_perm_b32 v62, v82, v80, s42
    v_mfma_f32_16x16x32_bf16 a[0:3], a[124:127], v[128:131], a[0:3]
    v_perm_b32 v66, v82, v80, s42
    v_perm_b32 v63, v82, v80, s43
    v_perm_b32 v67, v82, v80, s43
    v_mfma_f32_16x16x32_bf16 a[0:3], a[128:131], v[136:139], a[0:3]
    v_and_b32 v84, 0xffff0000, v52
    v_and_b32 v85, 0xffff0000, v53
    v_mfma_f32_16x16x32_bf16 a[0:3], a[132:135], v[144:147], a[0:3]
    s_add_u32 m0, s45, 93696
    v_mul_f32_e64 v80, v85, v84
    v_sub_f32_e64 v81, v84, v80
    v_mfma_f32_16x16x32_bf16 a[4:7], a[120:123], v[124:127], a[4:7]
    buffer_load_dwordx4 v8, s[16:19], 0 offen offset:512 lds
    v_fma_f32 v82, 2.0, v84, -v80
    v_mfma_f32_16x16x32_bf16 a[4:7], a[124:127], v[132:135], a[4:7]
    v_fma_f32 v83, s41, v84, -v80
    v_cvt_pk_bf16_f32 v80, -v80, v81
    v_cvt_pk_bf16_f32 v82, v82, v83
    v_mfma_f32_16x16x32_bf16 a[4:7], a[128:131], v[140:143], a[4:7]
    v_perm_b32 v64, v82, v80, s42
    v_perm_b32 v68, v82, v80, s42
    v_mfma_f32_16x16x32_bf16 a[4:7], a[132:135], v[148:151], a[4:7]
    v_perm_b32 v65, v82, v80, s43
    v_perm_b32 v69, v82, v80, s43
    v_mfma_f32_16x16x32_bf16 a[8:11], a[136:139], v[120:123], a[8:11]
    v_permlane16_swap_b32_e64 v62, v66
    v_mfma_f32_16x16x32_bf16 a[8:11], a[140:143], v[128:131], a[8:11]
    s_add_u32 m0, s45, 97536
    v_permlane16_swap_b32_e64 v63, v67
    v_mfma_f32_16x16x32_bf16 a[8:11], a[144:147], v[136:139], a[8:11]
    buffer_load_dwordx4 v1, s[16:19], 0 offen offset:768 lds
    v_permlane16_swap_b32_e64 v64, v68
    v_mfma_f32_16x16x32_bf16 a[8:11], a[148:151], v[144:147], a[8:11]
    v_permlane16_swap_b32_e64 v65, v69
    v_mfma_f32_16x16x32_bf16 a[12:15], a[136:139], v[124:127], a[12:15]
    s_waitcnt vmcnt(16)
    v_lshrrev_b64 v[70:71], 2, v[46:47]
    v_perm_b32 v72, v70, v46, s36
    v_perm_b32 v73, v70, v46, s37
    v_mfma_f32_16x16x32_bf16 a[12:15], a[140:143], v[132:135], a[12:15]
    s_addk_i32 m0, 4096
    v_and_or_b32 v152, v72, s40, v19
    v_lshrrev_b64 v[74:75], 4, v[72:73]
    v_mfma_f32_16x16x32_bf16 a[12:15], a[144:147], v[140:143], a[12:15]
L_padB0:
    s_cbranch_vccnz L_backB
    s_nop 0
    buffer_load_dwordx4 v2, s[16:19], 0 offen offset:768 lds
    v_and_or_b32 v154, v73, s40, v19
    v_mfma_f32_16x16x32_bf16 a[12:15], a[148:151], v[148:151], a[12:15]
    ds_read_b128 a[152:155], v26 offset:40960
    ds_read_b128 a[156:159], v27 offset:40960
    ds_read_b128 a[160:163], v28 offset:40960
    ds_read_b128 a[164:167], v29 offset:40960
    ds_read_b128 a[168:171], v26 offset:45056
    ds_read_b128 a[172:175], v27 offset:45056
    ds_read_b128 a[176:179], v28 offset:45056
    ds_read_b128 a[180:183], v29 offset:45056
    s_waitcnt lgkmcnt(0)
    v_mfma_f32_16x16x32_bf16 a[16:19], a[152:155], v[120:123], a[16:19]
    s_nop 0
    v_perm_b32 v152, v63, v62, v152
    v_and_or_b32 v153, v74, s40, v19
    v_mfma_f32_16x16x32_bf16 a[16:19], a[156:159], v[128:131], a[16:19]
    s_add_u32 m0, s45, 105728
    v_perm_b32 v154, v63, v62, v154
    v_and_or_b32 v155, v75, s40, v19
    v_perm_b32 v153, v63, v62, v153
    v_mfma_f32_16x16x32_bf16 a[16:19], a[160:163], v[136:139], a[16:19]
    buffer_load_dwordx4 v3, s[16:19], 0 offen offset:768 lds
    v_perm_b32 v155, v63, v62, v155
    v_mfma_f32_16x16x32_bf16 a[16:19], a[164:167], v[144:147], a[16:19]
    v_perm_b32 v76, v71, v47, s36
    v_perm_b32 v77, v71, v47, s37
    v_mfma_f32_16x16x32_bf16 a[20:23], a[152:155], v[124:127], a[20:23]
    v_and_or_b32 v156, v76, s40, v19
    v_lshrrev_b64 v[78:79], 4, v[76:77]
    v_mfma_f32_16x16x32_bf16 a[20:23], a[156:159], v[132:135], a[20:23]
    s_add_u32 m0, s45, 109824
    v_and_or_b32 v158, v77, s40, v19
    v_perm_b32 v156, v65, v64, v156
    v_and_or_b32 v157, v78, s40, v19
    v_mfma_f32_16x16x32_bf16 a[20:23], a[160:163], v[140:143], a[20:23]
    buffer_load_dwordx4 v4, s[16:19], 0 offen offset:768 lds
    v_perm_b32 v158, v65, v64, v158
    v_mfma_f32_16x16x32_bf16 a[20:23], a[164:167], v[148:151], a[20:23]
    s_waitcnt vmcnt(15)
    v_and_or_b32 v159, v79, s40, v19
    v_perm_b32 v157, v65, v64, v157
    v_mfma_f32_16x16x32_bf16 a[24:27], a[168:171], v[120:123], a[24:27]
    s_barrier
    v_mfma_f32_16x16x32_bf16 a[24:27], a[172:175], v[128:131], a[24:27]
    s_add_u32 m0, s45, 113920
    v_perm_b32 v159, v65, v64, v159
    v_perm_b32 v72, v70, v46, s38
    v_mfma_f32_16x16x32_bf16 a[24:27], a[176:179], v[136:139], a[24:27]
    buffer_load_dwordx4 v5, s[16:19], 0 offen offset:768 lds
    v_perm_b32 v73, v70, v46, s39
    v_and_or_b32 v160, v72, s40, v19
    v_mfma_f32_16x16x32_bf16 a[24:27], a[180:183], v[144:147], a[24:27]
    v_lshrrev_b64 v[74:75], 4, v[72:73]
    v_and_or_b32 v162, v73, s40, v19
    v_mfma_f32_16x16x32_bf16 a[28:31], a[168:171], v[124:127], a[28:31]
    buffer_load_dwordx2 v[40:41], v17, s[20:23], 0 offen
    v_perm_b32 v160, v63, v62, v160
    v_mfma_f32_16x16x32_bf16 a[28:31], a[172:175], v[132:135], a[28:31]
    s_add_u32 m0, s45, 118016
    v_and_or_b32 v161, v74, s40, v19
    v_perm_b32 v162, v63, v62, v162
    v_mfma_f32_16x16x32_bf16 a[28:31], a[176:179], v[140:143], a[28:31]
    buffer_load_dwordx4 v6, s[16:19], 0 offen offset:768 lds
    v_and_or_b32 v163, v75, s40, v19
    v_mfma_f32_16x16x32_bf16 a[28:31], a[180:183], v[148:151], a[28:31]
    ds_read_b128 a[120:123], v26 offset:49152
    ds_read_b128 a[124:127], v27 offset:49152
    ds_read_b128 a[128:131], v28 offset:49152
    ds_read_b128 a[132:135], v29 offset:49152
    ds_read_b128 a[136:139], v26 offset:53248
    ds_read_b128 a[140:143], v27 offset:53248
    ds_read_b128 a[144:147], v28 offset:53248
    ds_read_b128 a[148:151], v29 offset:53248
    s_waitcnt lgkmcnt(0)
    v_mfma_f32_16x16x32_bf16 a[32:35], a[120:123], v[120:123], a[32:35]
    s_nop 0
    v_perm_b32 v161, v63, v62, v161
    v_perm_b32 v163, v63, v62, v163
    v_perm_b32 v76, v71, v47, s38
    v_mfma_f32_16x16x32_bf16 a[32:35], a[124:127], v[128:131], a[32:35]
    s_add_u32 m0, s45, 122112
    v_perm_b32 v77, v71, v47, s39
    v_and_or_b32 v164, v76, s40, v19
    v_mfma_f32_16x16x32_bf16 a[32:35], a[128:131], v[136:139], a[32:35]
    buffer_load_dwordx4 v7, s[16:19], 0 offen offset:768 lds
    v_lshrrev_b64 v[78:79], 4, v[76:77]
    v_mfma_f32_16x16x32_bf16 a[32:35], a[132:135], v[144:147], a[32:35]
    v_and_or_b32 v166, v77, s40, v19
    v_perm_b32 v164, v65, v64, v164
    v_and_or_b32 v165, v78, s40, v19
    v_mfma_f32_16x16x32_bf16 a[36:39], a[120:123], v[124:127], a[36:39]
    buffer_load_dword v24, v25, s[16:19], 0 offen offset:1536
    v_perm_b32 v166, v65, v64, v166
    v_mfma_f32_16x16x32_bf16 a[36:39], a[124:127], v[132:135], a[36:39]
    s_add_u32 m0, s45, 126208
    v_and_or_b32 v167, v79, s40, v19
    v_perm_b32 v165, v65, v64, v165
    v_mfma_f32_16x16x32_bf16 a[36:39], a[128:131], v[140:143], a[36:39]
    buffer_load_dwordx4 v8, s[16:19], 0 offen offset:768 lds
    v_perm_b32 v167, v65, v64, v167
    v_mfma_f32_16x16x32_bf16 a[36:39], a[132:135], v[148:151], a[36:39]
    s_waitcnt vmcnt(20)
    v_lshlrev_b32 v84, 16, v50
    v_lshlrev_b32_e64 v85, 16, v51
    v_mfma_f32_16x16x32_bf16 a[40:43], a[136:139], v[120:123], a[40:43]
    v_mul_f32_e64 v80, v85, v84
    v_sub_f32_e64 v81, v84, v80
    v_lshrrev_b64 v[70:71], 2, v[48:49]
    v_mfma_f32_16x16x32_bf16 a[40:43], a[140:143], v[128:131], a[40:43]
    s_add_u32 m0, s45, 130048
    v_perm_b32 v72, v70, v48, s36
    v_perm_b32 v73, v70, v48, s37
    v_mfma_f32_16x16x32_bf16 a[40:43], a[144:147], v[136:139], a[40:43]
    buffer_load_dwordx4 v1, s[16:19], 0 offen offset:1024 lds
    v_and_or_b32 v168, v72, s40, v19
    v_mfma_f32_16x16x32_bf16 a[40:43], a[148:151], v[144:147], a[40:43]
    v_lshrrev_b64 v[74:75], 4, v[72:73]
    v_and_or_b32 v170, v73, s40, v19
    v_mfma_f32_16x16x32_bf16 a[44:47], a[136:139], v[124:127], a[44:47]
    v_perm_b32 v168, v63, v62, v168
    v_and_or_b32 v169, v74, s40, v19
    v_perm_b32 v170, v63, v62, v170
    v_mfma_f32_16x16x32_bf16 a[44:47], a[140:143], v[132:135], a[44:47]
    s_add_u32 m0, s45, 134144
    v_and_or_b32 v171, v75, s40, v19
    v_perm_b32 v169, v63, v62, v169
    v_mfma_f32_16x16x32_bf16 a[44:47], a[144:147], v[140:143], a[44:47]
    buffer_load_dwordx4 v2, s[16:19], 0 offen offset:1024 lds
    v_perm_b32 v171, v63, v62, v171
    v_mfma_f32_16x16x32_bf16 a[44:47], a[148:151], v[148:151], a[44:47]
    ds_read_b128 a[152:155], v26 offset:57344
    ds_read_b128 a[156:159], v27 offset:57344
    ds_read_b128 a[160:163], v28 offset:57344
    ds_read_b128 a[164:167], v29 offset:57344
    ds_read_b128 a[168:171], v26 offset:61440
    ds_read_b128 a[172:175], v27 offset:61440
    ds_read_b128 a[176:179], v28 offset:61440
    ds_read_b128 a[180:183], v29 offset:61440
    s_waitcnt lgkmcnt(0)
    v_mfma_f32_16x16x32_bf16 a[48:51], a[152:155], v[120:123], a[48:51]
    s_nop 0
    v_perm_b32 v76, v71, v49, s36
    v_perm_b32 v77, v71, v49, s37
    v_and_or_b32 v172, v76, s40, v19
    v_mfma_f32_16x16x32_bf16 a[48:51], a[156:159], v[128:131], a[48:51]
    s_add_u32 m0, s45, 138240
    v_lshrrev_b64 v[78:79], 4, v[76:77]
    v_and_or_b32 v174, v77, s40, v19
    v_mfma_f32_16x16x32_bf16 a[48:51], a[160:163], v[136:139], a[48:51]
    buffer_load_dwordx4 v3, s[16:19], 0 offen offset:1024 lds
    v_perm_b32 v172, v65, v64, v172
    v_mfma_f32_16x16x32_bf16 a[48:51], a[164:167], v[144:147], a[48:51]
    v_and_or_b32 v173, v78, s40, v19
    v_perm_b32 v174, v65, v64, v174
    v_mfma_f32_16x16x32_bf16 a[52:55], a[152:155], v[124:127], a[52:55]
    v_and_or_b32 v175, v79, s40, v19
    v_perm_b32 v173, v65, v64, v173
    v_perm_b32 v175, v65, v64, v175
    v_mfma_f32_16x16x32_bf16 a[52:55], a[156:159], v[132:135], a[52:55]
    s_add_u32 m0, s45, 142336
    v_fma_f32 v82, 2.0, v84, -v80
    v_fma_f32 v83, s41, v84, -v80
    v_mfma_f32_16x16x32_bf16 a[52:55], a[160:163], v[140:143], a[52:55]
    buffer_load_dwordx4 v4, s[16:19], 0 offen offset:1024 lds
    v_cvt_pk_bf16_f32 v80, -v80, v81
    v_mfma_f32_16x16x32_bf16 a[52:55], a[164:167], v[148:151], a[52:55]
    s_waitcnt vmcnt(17)
    v_cvt_pk_bf16_f32 v82, v82, v83
    v_perm_b32 v54, v82, v80, s42
    v_mfma_f32_16x16x32_bf16 v[248:251], a[168:171], v[120:123], v[248:251]
    s_barrier
    v_mfma_f32_16x16x32_bf16 v[248:251], a[172:175], v[128:131], v[248:251]
    s_add_u32 m0, s45, 146432
    v_perm_b32 v72, v70, v48, s38
    v_perm_b32 v73, v70, v48, s39
    v_and_or_b32 v176, v72, s40, v19
    v_mfma_f32_16x16x32_bf16 v[248:251], a[176:179], v[136:139], v[248:251]
    buffer_load_dwordx4 v5, s[16:19], 0 offen offset:1024 lds
    v_lshrrev_b64 v[74:75], 4, v[72:73]
    v_mfma_f32_16x16x32_bf16 v[248:251], a[180:183], v[144:147], v[248:251]
    s_mov_b64 s[20:21], s[72:73]
    v_and_or_b32 v178, v73, s40, v19
    v_perm_b32 v176, v63, v62, v176
    v_mfma_f32_16x16x32_bf16 v[252:255], a[168:171], v[124:127], v[252:255]
    buffer_load_dwordx2 v[42:43], v16, s[20:23], 0 offen
    v_and_or_b32 v177, v74, s40, v19
    v_mfma_f32_16x16x32_bf16 v[252:255], a[172:175], v[132:135], v[252:255]
    s_addk_i32 m0, 4096
    v_perm_b32 v178, v63, v62, v178
    v_and_or_b32 v179, v75, s40, v19
    v_perm_b32 v177, v63, v62, v177
    v_mfma_f32_16x16x32_bf16 v[252:255], a[176:179], v[140:143], v[252:255]
    buffer_load_dwordx4 v6, s[16:19], 0 offen offset:1024 lds
    v_perm_b32 v179, v63, v62, v179
    v_mfma_f32_16x16x32_bf16 v[252:255], a[180:183], v[148:151], v[252:255]
    ds_read_b128 a[120:123], v30 offset:0
    ds_read_b128 a[124:127], v31 offset:0
    ds_read_b128 a[128:131], v32 offset:0
    ds_read_b128 a[132:135], v33 offset:0
    ds_read_b128 a[136:139], v30 offset:4096
    ds_read_b128 a[140:143], v31 offset:4096
    ds_read_b128 a[144:147], v32 offset:4096
    ds_read_b128 a[148:151], v33 offset:4096
    s_waitcnt lgkmcnt(0)
    v_mfma_f32_16x16x32_bf16 a[0:3], a[120:123], v[152:155], a[0:3]
    s_nop 0
    v_perm_b32 v76, v71, v49, s38
    v_perm_b32 v77, v71, v49, s39
    v_mfma_f32_16x16x32_bf16 a[0:3], a[124:127], v[160:163], a[0:3]
    s_add_u32 m0, s45, 154624
    v_and_or_b32 v180, v76, s40, v19
    v_lshrrev_b64 v[78:79], 4, v[76:77]
    v_mfma_f32_16x16x32_bf16 a[0:3], a[128:131], v[168:171], a[0:3]
    buffer_load_dwordx4 v7, s[16:19], 0 offen offset:1024 lds
    v_and_or_b32 v182, v77, s40, v19
    v_mfma_f32_16x16x32_bf16 a[0:3], a[132:135], v[176:179], a[0:3]
    v_perm_b32 v180, v65, v64, v180
    v_and_or_b32 v181, v78, s40, v19
    v_perm_b32 v182, v65, v64, v182
    v_mfma_f32_16x16x32_bf16 a[4:7], a[120:123], v[156:159], a[4:7]
    v_and_or_b32 v183, v79, s40, v19
    v_perm_b32 v181, v65, v64, v181
    v_mfma_f32_16x16x32_bf16 a[4:7], a[124:127], v[164:167], a[4:7]
    s_add_u32 m0, s45, 158720
    v_perm_b32 v183, v65, v64, v183
    v_perm_b32 v58, v82, v80, s42
    v_mfma_f32_16x16x32_bf16 a[4:7], a[128:131], v[172:175], a[4:7]
    buffer_load_dwordx4 v8, s[16:19], 0 offen offset:1024 lds
    v_perm_b32 v55, v82, v80, s43
    v_perm_b32 v59, v82, v80, s43
    v_mfma_f32_16x16x32_bf16 a[4:7], a[132:135], v[180:183], a[4:7]
    v_and_b32 v84, 0xffff0000, v50
    v_and_b32 v85, 0xffff0000, v51
    v_mfma_f32_16x16x32_bf16 a[8:11], a[136:139], v[152:155], a[8:11]
    s_movk_i32 s49, 1280
    v_lshrrev_b64 v[70:71], 2, v[38:39]
    v_perm_b32 v72, v70, v38, s36
    v_mfma_f32_16x16x32_bf16 a[8:11], a[140:143], v[160:163], a[8:11]
    s_mov_b32 m0, s45
    v_perm_b32 v73, v70, v38, s37
    v_and_or_b32 v184, v72, s40, v19
    v_mfma_f32_16x16x32_bf16 a[8:11], a[144:147], v[168:171], a[8:11]
    buffer_load_dwordx4 v1, s[16:19], s49 offen lds
    v_mfma_f32_16x16x32_bf16 a[8:11], a[148:151], v[176:179], a[8:11]
    v_lshrrev_b64 v[74:75], 4, v[72:73]
    v_and_or_b32 v186, v73, s40, v19
    v_perm_b32 v184, v67, v66, v184
    v_mfma_f32_16x16x32_bf16 a[12:15], a[136:139], v[156:159], a[12:15]
    v_and_or_b32 v185, v74, s40, v19
    v_perm_b32 v186, v67, v66, v186
    v_mfma_f32_16x16x32_bf16 a[12:15], a[140:143], v[164:167], a[12:15]
    s_add_u32 m0, s45, 2816
    v_and_or_b32 v187, v75, s40, v19
    v_perm_b32 v185, v67, v66, v185
    v_mfma_f32_16x16x32_bf16 a[12:15], a[144:147], v[172:175], a[12:15]
    buffer_load_dwordx4 v2, s[16:19], 0 offen offset:1280 lds
    v_perm_b32 v187, v67, v66, v187
    v_mfma_f32_16x16x32_bf16 a[12:15], a[148:151], v[180:183], a[12:15]
    s_mov_b64 s[24:25], s[88:89]
    ds_read_b128 a[152:155], v30 offset:8192
    ds_read_b128 a[156:159], v31 offset:8192
    ds_read_b128 a[160:163], v32 offset:8192
    ds_read_b128 a[164:167], v33 offset:8192
    ds_read_b128 a[168:171], v30 offset:12288
    ds_read_b128 a[172:175], v31 offset:12288
    ds_read_b128 a[176:179], v32 offset:12288
    ds_read_b128 a[180:183], v33 offset:12288
    s_waitcnt lgkmcnt(0)
    v_mfma_f32_16x16x32_bf16 a[16:19], a[152:155], v[152:155], a[16:19]
    buffer_load_dword v52, v18, s[24:27], 0 offen
    v_perm_b32 v76, v71, v39, s36
    v_perm_b32 v77, v71, v39, s37
    v_mfma_f32_16x16x32_bf16 a[16:19], a[156:159], v[160:163], a[16:19]
    s_add_u32 m0, s45, 6912
    v_and_or_b32 v188, v76, s40, v19
    v_lshrrev_b64 v[78:79], 4, v[76:77]
    v_mfma_f32_16x16x32_bf16 a[16:19], a[160:163], v[168:171], a[16:19]
    buffer_load_dwordx4 v3, s[16:19], 0 offen offset:1280 lds
    v_and_or_b32 v190, v77, s40, v19
    v_mfma_f32_16x16x32_bf16 a[16:19], a[164:167], v[176:179], a[16:19]
    s_mov_b64 s[28:29], s[90:91]
    v_perm_b32 v188, v69, v68, v188
    v_and_or_b32 v189, v78, s40, v19
    v_mfma_f32_16x16x32_bf16 a[20:23], a[152:155], v[156:159], a[20:23]
    buffer_load_dword v53, v18, s[28:31], 0 offen
    v_perm_b32 v190, v69, v68, v190
    v_and_or_b32 v191, v79, s40, v19
    v_mfma_f32_16x16x32_bf16 a[20:23], a[156:159], v[164:167], a[20:23]
    s_addk_i32 m0, 4096
    v_perm_b32 v189, v69, v68, v189
    v_perm_b32 v191, v69, v68, v191
    v_mfma_f32_16x16x32_bf16 a[20:23], a[160:163], v[172:175], a[20:23]
    buffer_load_dwordx4 v4, s[16:19], 0 offen offset:1280 lds
    v_mul_f32_e64 v80, v85, v84
    v_mfma_f32_16x16x32_bf16 a[20:23], a[164:167], v[180:183], a[20:23]
    v_sub_f32_e64 v81, v84, v80
    v_fma_f32 v82, 2.0, v84, -v80
    v_mfma_f32_16x16x32_bf16 a[24:27], a[168:171], v[152:155], a[24:27]
    buffer_load_dwordx2 v[44:45], v17, s[20:23], 0 offen
    v_fma_f32 v83, s41, v84, -v80
    v_mfma_f32_16x16x32_bf16 a[24:27], a[172:175], v[160:163], a[24:27]
    s_add_u32 m0, s45, 15104
    v_perm_b32 v72, v70, v38, s38
    v_perm_b32 v73, v70, v38, s39
    v_and_or_b32 v192, v72, s40, v19
    v_mfma_f32_16x16x32_bf16 a[24:27], a[176:179], v[168:171], a[24:27]
    buffer_load_dwordx4 v5, s[16:19], 0 offen offset:1280 lds
    v_lshrrev_b64 v[74:75], 4, v[72:73]
    v_mfma_f32_16x16x32_bf16 a[24:27], a[180:183], v[176:179], a[24:27]
    v_and_or_b32 v194, v73, s40, v19
    v_perm_b32 v192, v67, v66, v192
    v_mfma_f32_16x16x32_bf16 a[28:31], a[168:171], v[156:159], a[28:31]
    v_and_or_b32 v193, v74, s40, v19
    v_perm_b32 v194, v67, v66, v194
    v_mfma_f32_16x16x32_bf16 a[28:31], a[172:175], v[164:167], a[28:31]
    s_add_u32 m0, s45, 19200
    v_and_or_b32 v195, v75, s40, v19
    v_perm_b32 v193, v67, v66, v193
    v_perm_b32 v195, v67, v66, v195
    v_mfma_f32_16x16x32_bf16 a[28:31], a[176:179], v[172:175], a[28:31]
    buffer_load_dwordx4 v6, s[16:19], 0 offen offset:1280 lds
    v_perm_b32 v76, v71, v39, s38
    v_mfma_f32_16x16x32_bf16 a[28:31], a[180:183], v[180:183], a[28:31]
    ds_read_b128 a[120:123], v30 offset:16384
    ds_read_b128 a[124:127], v31 offset:16384
    ds_read_b128 a[128:131], v32 offset:16384
    ds_read_b128 a[132:135], v33 offset:16384
    ds_read_b128 a[136:139], v30 offset:20480
    ds_read_b128 a[140:143], v31 offset:20480
    ds_read_b128 a[144:147], v32 offset:20480
    ds_read_b128 a[148:151], v33 offset:20480
    s_waitcnt lgkmcnt(0)
    v_mfma_f32_16x16x32_bf16 a[32:35], a[120:123], v[152:155], a[32:35]
    s_nop 0
    v_perm_b32 v77, v71, v39, s39
    v_and_or_b32 v196, v76, s40, v19
    v_mfma_f32_16x16x32_bf16 a[32:35], a[124:127], v[160:163], a[32:35]
    s_add_u32 m0, s45, 23296
    v_lshrrev_b64 v[78:79], 4, v[76:77]
    v_and_or_b32 v198, v77, s40, v19
    v_perm_b32 v196, v69, v68, v196
    v_mfma_f32_16x16x32_bf16 a[32:35], a[128:131], v[168:171], a[32:35]
    buffer_load_dwordx4 v7, s[16:19], 0 offen offset:1280 lds
    v_and_or_b32 v197, v78, s40, v19
    v_mfma_f32_16x16x32_bf16 a[32:35], a[132:135], v[176:179], a[32:35]
    v_perm_b32 v198, v69, v68, v198
    v_and_or_b32 v199, v79, s40, v19
    v_mfma_f32_16x16x32_bf16 a[36:39], a[120:123], v[156:159], a[36:39]
    v_perm_b32 v197, v69, v68, v197
    v_perm_b32 v199, v69, v68, v199
    v_mfma_f32_16x16x32_bf16 a[36:39], a[124:127], v[164:167], a[36:39]
    s_add_u32 m0, s45, 27392
    v_cvt_pk_bf16_f32 v80, -v80, v81
    v_cvt_pk_bf16_f32 v82, v82, v83
    v_perm_b32 v56, v82, v80, s42
    v_mfma_f32_16x16x32_bf16 a[36:39], a[128:131], v[172:175], a[36:39]
    buffer_load_dwordx4 v8, s[16:19], 0 offen offset:1280 lds
    v_perm_b32 v60, v82, v80, s42
    v_mfma_f32_16x16x32_bf16 a[36:39], a[132:135], v[180:183], a[36:39]
    s_waitcnt vmcnt(24)
    v_perm_b32 v57, v82, v80, s43
    v_lshrrev_b64 v[70:71], 2, v[40:41]
    v_mfma_f32_16x16x32_bf16 a[40:43], a[136:139], v[152:155], a[40:43]
    s_barrier
    v_mfma_f32_16x16x32_bf16 a[40:43], a[140:143], v[160:163], a[40:43]
    s_add_u32 m0, s45, 31232
    v_perm_b32 v72, v70, v40, s36
    v_perm_b32 v73, v70, v40, s37
    v_mfma_f32_16x16x32_bf16 a[40:43], a[144:147], v[168:171], a[40:43]
    buffer_load_dwordx4 v1, s[16:19], 0 offen offset:1536 lds
    v_and_or_b32 v200, v72, s40, v19
    v_lshrrev_b64 v[74:75], 4, v[72:73]
    v_mfma_f32_16x16x32_bf16 a[40:43], a[148:151], v[176:179], a[40:43]
    v_and_or_b32 v202, v73, s40, v19
    v_perm_b32 v200, v67, v66, v200
    v_mfma_f32_16x16x32_bf16 a[44:47], a[136:139], v[156:159], a[44:47]
    v_and_or_b32 v201, v74, s40, v19
    v_perm_b32 v202, v67, v66, v202
    v_mfma_f32_16x16x32_bf16 a[44:47], a[140:143], v[164:167], a[44:47]
    s_add_u32 m0, s45, 35328
    v_and_or_b32 v203, v75, s40, v19
    v_perm_b32 v201, v67, v66, v201
    v_mfma_f32_16x16x32_bf16 a[44:47], a[144:147], v[172:175], a[44:47]
    buffer_load_dwordx4 v2, s[16:19], 0 offen offset:1536 lds
    v_perm_b32 v203, v67, v66, v203
    v_perm_b32 v76, v71, v41, s36
    v_mfma_f32_16x16x32_bf16 a[44:47], a[148:151], v[180:183], a[44:47]
    ds_read_b128 a[152:155], v30 offset:24576
    ds_read_b128 a[156:159], v31 offset:24576
    ds_read_b128 a[160:163], v32 offset:24576
    ds_read_b128 a[164:167], v33 offset:24576
    ds_read_b128 a[168:171], v30 offset:28672
    ds_read_b128 a[172:175], v31 offset:28672
    ds_read_b128 a[176:179], v32 offset:28672
    ds_read_b128 a[180:183], v33 offset:28672
    s_waitcnt lgkmcnt(0)
    v_mfma_f32_16x16x32_bf16 a[48:51], a[152:155], v[152:155], a[48:51]
    s_nop 0
    v_perm_b32 v77, v71, v41, s37
    v_and_or_b32 v204, v76, s40, v19
    v_mfma_f32_16x16x32_bf16 a[48:51], a[156:159], v[160:163], a[48:51]
    s_add_u32 m0, s45, 39424
    v_lshrrev_b64 v[78:79], 4, v[76:77]
    v_and_or_b32 v206, v77, s40, v19
    v_mfma_f32_16x16x32_bf16 a[48:51], a[160:163], v[168:171], a[48:51]
    buffer_load_dwordx4 v3, s[16:19], 0 offen offset:1536 lds
    v_perm_b32 v204, v69, v68, v204
    v_mfma_f32_16x16x32_bf16 a[48:51], a[164:167], v[176:179], a[48:51]
    v_and_or_b32 v205, v78, s40, v19
    v_perm_b32 v206, v69, v68, v206
    v_and_or_b32 v207, v79, s40, v19
    v_mfma_f32_16x16x32_bf16 a[52:55], a[152:155], v[156:159], a[52:55]
    s_mov_b64 s[20:21], s[74:75]
    v_perm_b32 v205, v69, v68, v205
    v_perm_b32 v207, v69, v68, v207
    v_mfma_f32_16x16x32_bf16 a[52:55], a[156:159], v[164:167], a[52:55]
    s_addk_i32 m0, 4096
    v_perm_b32 v61, v82, v80, s43
    v_perm_b32 v72, v70, v40, s38
    v_mfma_f32_16x16x32_bf16 a[52:55], a[160:163], v[172:175], a[52:55]
    buffer_load_dwordx4 v4, s[16:19], 0 offen offset:1536 lds
    v_perm_b32 v73, v70, v40, s39
    v_mfma_f32_16x16x32_bf16 a[52:55], a[164:167], v[180:183], a[52:55]
    v_permlane16_swap_b32_e64 v54, v58
    v_mfma_f32_16x16x32_bf16 v[248:251], a[168:171], v[152:155], v[248:251]
    buffer_load_dwordx2 v[46:47], v16, s[20:23], 0 offen
    v_and_or_b32 v208, v72, s40, v19
    v_mfma_f32_16x16x32_bf16 v[248:251], a[172:175], v[160:163], v[248:251]
    s_add_u32 m0, s45, 47616
    v_permlane16_swap_b32_e64 v55, v59
    v_mfma_f32_16x16x32_bf16 v[248:251], a[176:179], v[168:171], v[248:251]
    buffer_load_dwordx4 v5, s[16:19], 0 offen offset:1536 lds
    v_lshrrev_b64 v[74:75], 4, v[72:73]
    v_mfma_f32_16x16x32_bf16 v[248:251], a[180:183], v[176:179], v[248:251]
    v_permlane16_swap_b32_e64 v56, v60
    v_permlane16_swap_b32_e64 v57, v61
    v_mfma_f32_16x16x32_bf16 v[252:255], a[168:171], v[156:159], v[252:255]
    v_and_or_b32 v210, v73, s40, v19
    v_perm_b32 v208, v67, v66, v208
    v_mfma_f32_16x16x32_bf16 v[252:255], a[172:175], v[164:167], v[252:255]
    s_add_u32 m0, s45, 51712
    v_and_or_b32 v209, v74, s40, v19
    v_perm_b32 v210, v67, v66, v210
    v_mfma_f32_16x16x32_bf16 v[252:255], a[176:179], v[172:175], v[252:255]
    buffer_load_dwordx4 v6, s[16:19], 0 offen offset:1536 lds
    v_and_or_b32 v211, v75, s40, v19
    v_perm_b32 v209, v67, v66, v209
    v_mfma_f32_16x16x32_bf16 v[252:255], a[180:183], v[180:183], v[252:255]
    ds_read_b128 a[120:123], v30 offset:32768
    ds_read_b128 a[124:127], v31 offset:32768
    ds_read_b128 a[128:131], v32 offset:32768
    ds_read_b128 a[132:135], v33 offset:32768
    ds_read_b128 a[136:139], v30 offset:36864
    ds_read_b128 a[140:143], v31 offset:36864
    ds_read_b128 a[144:147], v32 offset:36864
    ds_read_b128 a[148:151], v33 offset:36864
    s_waitcnt lgkmcnt(0)
    v_mfma_f32_16x16x32_bf16 a[0:3], a[120:123], v[184:187], a[0:3]
    s_nop 0
    v_perm_b32 v211, v67, v66, v211
    v_perm_b32 v76, v71, v41, s38
    v_mfma_f32_16x16x32_bf16 a[0:3], a[124:127], v[192:195], a[0:3]
    s_add_u32 m0, s45, 55808
    v_perm_b32 v77, v71, v41, s39
    v_and_or_b32 v212, v76, s40, v19
    v_mfma_f32_16x16x32_bf16 a[0:3], a[128:131], v[200:203], a[0:3]
    buffer_load_dwordx4 v7, s[16:19], 0 offen offset:1536 lds
    v_lshrrev_b64 v[78:79], 4, v[76:77]
    v_mfma_f32_16x16x32_bf16 a[0:3], a[132:135], v[208:211], a[0:3]
    v_and_or_b32 v214, v77, s40, v19
    v_perm_b32 v212, v69, v68, v212
    v_mfma_f32_16x16x32_bf16 a[4:7], a[120:123], v[188:191], a[4:7]
    s_waitcnt vmcnt(22)
    v_and_or_b32 v213, v78, s40, v19
    v_perm_b32 v214, v69, v68, v214
    v_and_or_b32 v215, v79, s40, v19
    v_mfma_f32_16x16x32_bf16 a[4:7], a[124:127], v[196:199], a[4:7]
    s_addk_i32 m0, 4096
    v_perm_b32 v213, v69, v68, v213
    v_perm_b32 v215, v69, v68, v215
    v_mfma_f32_16x16x32_bf16 a[4:7], a[128:131], v[204:207], a[4:7]
    buffer_load_dwordx4 v8, s[16:19], 0 offen offset:1536 lds
    v_lshrrev_b64 v[70:71], 2, v[42:43]
    v_mfma_f32_16x16x32_bf16 a[4:7], a[132:135], v[212:215], a[4:7]
    v_perm_b32 v72, v70, v42, s36
    v_perm_b32 v73, v70, v42, s37
    v_mfma_f32_16x16x32_bf16 a[8:11], a[136:139], v[184:187], a[8:11]
    v_and_or_b32 v216, v72, s40, v19
    v_lshrrev_b64 v[74:75], 4, v[72:73]
    v_and_or_b32 v218, v73, s40, v19
    v_mfma_f32_16x16x32_bf16 a[8:11], a[140:143], v[192:195], a[8:11]
    s_add_u32 m0, s45, 63744
    v_perm_b32 v216, v55, v54, v216
    v_and_or_b32 v217, v74, s40, v19
    v_mfma_f32_16x16x32_bf16 a[8:11], a[144:147], v[200:203], a[8:11]
    buffer_load_dwordx4 v1, s[16:19], 0 offen offset:1792 lds
    v_perm_b32 v218, v55, v54, v218
    v_mfma_f32_16x16x32_bf16 a[8:11], a[148:151], v[208:211], a[8:11]
    v_and_or_b32 v219, v75, s40, v19
    v_perm_b32 v217, v55, v54, v217
    v_mfma_f32_16x16x32_bf16 a[12:15], a[136:139], v[188:191], a[12:15]
    v_perm_b32 v219, v55, v54, v219
    v_perm_b32 v76, v71, v43, s36
    v_mfma_f32_16x16x32_bf16 a[12:15], a[140:143], v[196:199], a[12:15]
    s_add_u32 m0, s45, 67840
    v_perm_b32 v77, v71, v43, s37
    v_and_or_b32 v220, v76, s40, v19
    v_mfma_f32_16x16x32_bf16 a[12:15], a[144:147], v[204:207], a[12:15]
    buffer_load_dwordx4 v2, s[16:19], 0 offen offset:1792 lds
    v_lshrrev_b64 v[78:79], 4, v[76:77]
    v_and_or_b32 v222, v77, s40, v19
    v_mfma_f32_16x16x32_bf16 a[12:15], a[148:151], v[212:215], a[12:15]
    ds_read_b128 a[152:155], v30 offset:40960
    ds_read_b128 a[156:159], v31 offset:40960
    ds_read_b128 a[160:163], v32 offset:40960
    ds_read_b128 a[164:167], v33 offset:40960
    ds_read_b128 a[168:171], v30 offset:45056
    ds_read_b128 a[172:175], v31 offset:45056
    ds_read_b128 a[176:179], v32 offset:45056
    ds_read_b128 a[180:183], v33 offset:45056
    s_waitcnt lgkmcnt(0)
    v_mfma_f32_16x16x32_bf16 a[16:19], a[152:155], v[184:187], a[16:19]
    s_nop 0
    v_perm_b32 v220, v57, v56, v220
    v_and_or_b32 v221, v78, s40, v19
    v_mfma_f32_16x16x32_bf16 a[16:19], a[156:159], v[192:195], a[16:19]
    s_add_u32 m0, s45, 71936
    v_perm_b32 v222, v57, v56, v222
    v_and_or_b32 v223, v79, s40, v19
    v_mfma_f32_16x16x32_bf16 a[16:19], a[160:163], v[200:203], a[16:19]
L_padB1:
    s_cbranch_vccnz L_backB
    s_nop 0
    buffer_load_dwordx4 v3, s[16:19], 0 offen offset:1792 lds
    v_perm_b32 v221, v57, v56, v221
    v_mfma_f32_16x16x32_bf16 a[16:19], a[164:167], v[208:211], a[16:19]
    v_perm_b32 v223, v57, v56, v223
    v_perm_b32 v72, v70, v42, s38
    v_mfma_f32_16x16x32_bf16 a[20:23], a[152:155], v[188:191], a[20:23]
    v_perm_b32 v73, v70, v42, s39
    v_and_or_b32 v224, v72, s40, v19
    v_mfma_f32_16x16x32_bf16 a[20:23], a[156:159], v[196:199], a[20:23]
    s_add_u32 m0, s45, 76032
    v_lshrrev_b64 v[74:75], 4, v[72:73]
    v_and_or_b32 v226, v73, s40, v19
    v_perm_b32 v224, v55, v54, v224
    v_mfma_f32_16x16x32_bf16 a[20:23], a[160:163], v[204:207], a[20:23]
    buffer_load_dwordx4 v4, s[16:19], 0 offen offset:1792 lds
    v_and_or_b32 v225, v74, s40, v19
    v_mfma_f32_16x16x32_bf16 a[20:23], a[164:167], v[212:215], a[20:23]
    v_perm_b32 v226, v55, v54, v226
    v_and_or_b32 v227, v75, s40, v19
    v_mfma_f32_16x16x32_bf16 a[24:27], a[168:171], v[184:187], a[24:27]
    s_barrier
    v_mfma_f32_16x16x32_bf16 a[24:27], a[172:175], v[192:195], a[24:27]
    s_addk_i32 m0, 4096
    v_perm_b32 v225, v55, v54, v225
    v_perm_b32 v227, v55, v54, v227
    v_mfma_f32_16x16x32_bf16 a[24:27], a[176:179], v[200:203], a[24:27]
    buffer_load_dwordx4 v5, s[16:19], 0 offen offset:1792 lds
    v_perm_b32 v76, v71, v43, s38
    v_mfma_f32_16x16x32_bf16 a[24:27], a[180:183], v[208:211], a[24:27]
    v_perm_b32 v77, v71, v43, s39
    v_and_or_b32 v228, v76, s40, v19
    v_mfma_f32_16x16x32_bf16 a[28:31], a[168:171], v[188:191], a[28:31]
    buffer_load_dwordx2 v[48:49], v17, s[20:23], 0 offen
    v_lshrrev_b64 v[78:79], 4, v[76:77]
    v_mfma_f32_16x16x32_bf16 a[28:31], a[172:175], v[196:199], a[28:31]
    s_add_u32 m0, s45, 84224
    v_and_or_b32 v230, v77, s40, v19
    v_perm_b32 v228, v57, v56, v228
    v_and_or_b32 v229, v78, s40, v19
    v_mfma_f32_16x16x32_bf16 a[28:31], a[176:179], v[204:207], a[28:31]
    buffer_load_dwordx4 v6, s[16:19], 0 offen offset:1792 lds
    v_perm_b32 v230, v57, v56, v230
    v_mfma_f32_16x16x32_bf16 a[28:31], a[180:183], v[212:215], a[28:31]
    ds_read_b128 a[120:123], v30 offset:49152
    ds_read_b128 a[124:127], v31 offset:49152
    ds_read_b128 a[128:131], v32 offset:49152
    ds_read_b128 a[132:135], v33 offset:49152
    ds_read_b128 a[136:139], v30 offset:53248
    ds_read_b128 a[140:143], v31 offset:53248
    ds_read_b128 a[144:147], v32 offset:53248
    ds_read_b128 a[148:151], v33 offset:53248
    s_waitcnt lgkmcnt(0)
    v_mfma_f32_16x16x32_bf16 a[32:35], a[120:123], v[184:187], a[32:35]
    s_waitcnt vmcnt(22)
    v_and_or_b32 v231, v79, s40, v19
    v_perm_b32 v229, v57, v56, v229
    v_mfma_f32_16x16x32_bf16 a[32:35], a[124:127], v[192:195], a[32:35]
    s_add_u32 m0, s45, 88320
    v_perm_b32 v231, v57, v56, v231
    v_lshlrev_b32_e64 v84, 16, v52
    v_mfma_f32_16x16x32_bf16 a[32:35], a[128:131], v[200:203], a[32:35]
    buffer_load_dwordx4 v7, s[16:19], 0 offen offset:1792 lds
    v_lshlrev_b32_e64 v85, 16, v53
    v_mfma_f32_16x16x32_bf16 a[32:35], a[132:135], v[208:211], a[32:35]
    v_mul_f32_e64 v80, v85, v84
    v_sub_f32_e64 v81, v84, v80
    v_mfma_f32_16x16x32_bf16 a[36:39], a[120:123], v[188:191], a[36:39]
    s_waitcnt vmcnt(21)
    v_lshrrev_b64 v[70:71], 2, v[44:45]
    v_perm_b32 v72, v70, v44, s36
    v_mfma_f32_16x16x32_bf16 a[36:39], a[124:127], v[196:199], a[36:39]
    s_addk_i32 m0, 4096
    v_perm_b32 v73, v70, v44, s37
    v_and_or_b32 v232, v72, s40, v19
    v_lshrrev_b64 v[74:75], 4, v[72:73]
    v_mfma_f32_16x16x32_bf16 a[36:39], a[128:131], v[204:207], a[36:39]
    buffer_load_dwordx4 v8, s[16:19], 0 offen offset:1792 lds
    v_and_or_b32 v234, v73, s40, v19
    v_mfma_f32_16x16x32_bf16 a[36:39], a[132:135], v[212:215], a[36:39]
    v_perm_b32 v232, v55, v54, v232
    v_and_or_b32 v233, v74, s40, v19
    v_mfma_f32_16x16x32_bf16 a[40:43], a[136:139], v[184:187], a[40:43]
    v_perm_b32 v234, v55, v54, v234
    v_and_or_b32 v235, v75, s40, v19
    v_mfma_f32_16x16x32_bf16 a[40:43], a[140:143], v[192:195], a[40:43]
    v_perm_b32 v233, v55, v54, v233
    v_perm_b32 v235, v55, v54, v235
    v_mfma_f32_16x16x32_bf16 a[40:43], a[144:147], v[200:203], a[40:43]
    v_perm_b32 v76, v71, v45, s36
    v_perm_b32 v77, v71, v45, s37
    v_and_or_b32 v236, v76, s40, v19
    v_mfma_f32_16x16x32_bf16 a[40:43], a[148:151], v[208:211], a[40:43]
    v_lshrrev_b64 v[78:79], 4, v[76:77]
    v_and_or_b32 v238, v77, s40, v19
    v_mfma_f32_16x16x32_bf16 a[44:47], a[136:139], v[188:191], a[44:47]
    v_perm_b32 v236, v57, v56, v236
    v_and_or_b32 v237, v78, s40, v19
    v_mfma_f32_16x16x32_bf16 a[44:47], a[140:143], v[196:199], a[44:47]
    v_perm_b32 v238, v57, v56, v238
    v_and_or_b32 v239, v79, s40, v19
    v_mfma_f32_16x16x32_bf16 a[44:47], a[144:147], v[204:207], a[44:47]
    v_perm_b32 v237, v57, v56, v237
    v_perm_b32 v239, v57, v56, v239
    v_mfma_f32_16x16x32_bf16 a[44:47], a[148:151], v[212:215], a[44:47]
    ds_read_b128 a[152:155], v30 offset:57344
    ds_read_b128 a[156:159], v31 offset:57344
    ds_read_b128 a[160:163], v32 offset:57344
    ds_read_b128 a[164:167], v33 offset:57344
    ds_read_b128 a[168:171], v30 offset:61440
    ds_read_b128 a[172:175], v31 offset:61440
    ds_read_b128 a[176:179], v32 offset:61440
    ds_read_b128 a[180:183], v33 offset:61440
    s_waitcnt lgkmcnt(0)
    v_mfma_f32_16x16x32_bf16 a[48:51], a[152:155], v[184:187], a[48:51]
    s_nop 0
    v_fma_f32 v82, 2.0, v84, -v80
    v_fma_f32 v83, s41, v84, -v80
    v_mfma_f32_16x16x32_bf16 a[48:51], a[156:159], v[192:195], a[48:51]
    v_cvt_pk_bf16_f32 v80, -v80, v81
    v_cvt_pk_bf16_f32 v82, v82, v83
    v_perm_b32 v62, v82, v80, s42
    v_mfma_f32_16x16x32_bf16 a[48:51], a[160:163], v[200:203], a[48:51]
    v_perm_b32 v72, v70, v44, s38
    v_perm_b32 v73, v70, v44, s39
    v_mfma_f32_16x16x32_bf16 a[48:51], a[164:167], v[208:211], a[48:51]
    v_and_or_b32 v240, v72, s40, v19
    v_lshrrev_b64 v[74:75], 4, v[72:73]
    v_mfma_f32_16x16x32_bf16 a[52:55], a[152:155], v[188:191], a[52:55]
    v_and_or_b32 v242, v73, s40, v19
    v_perm_b32 v240, v55, v54, v240
    v_mfma_f32_16x16x32_bf16 a[52:55], a[156:159], v[196:199], a[52:55]
    s_mov_b64 s[20:21], s[76:77]
    v_and_or_b32 v241, v74, s40, v19
    v_perm_b32 v242, v55, v54, v242
    v_mfma_f32_16x16x32_bf16 a[52:55], a[160:163], v[204:207], a[52:55]
    buffer_load_dwordx2 v[38:39], v16, s[20:23], 0 offen
    v_and_or_b32 v243, v75, s40, v19
    v_mfma_f32_16x16x32_bf16 a[52:55], a[164:167], v[212:215], a[52:55]
    s_nop 0
    v_perm_b32 v241, v55, v54, v241
    v_perm_b32 v243, v55, v54, v243
    v_perm_b32 v76, v71, v45, s38
    v_mfma_f32_16x16x32_bf16 v[248:251], a[168:171], v[184:187], v[248:251]
    s_barrier
    v_mfma_f32_16x16x32_bf16 v[248:251], a[172:175], v[192:195], v[248:251]
    s_nop 0
    v_perm_b32 v77, v71, v45, s39
    v_and_or_b32 v244, v76, s40, v19
    v_mfma_f32_16x16x32_bf16 v[248:251], a[176:179], v[200:203], v[248:251]
    v_lshrrev_b64 v[78:79], 4, v[76:77]
    v_and_or_b32 v246, v77, s40, v19
    v_mfma_f32_16x16x32_bf16 v[248:251], a[180:183], v[208:211], v[248:251]
    v_perm_b32 v244, v57, v56, v244
    v_and_or_b32 v245, v78, s40, v19
    v_mfma_f32_16x16x32_bf16 v[252:255], a[168:171], v[188:191], v[252:255]
    v_perm_b32 v246, v57, v56, v246
    v_and_or_b32 v247, v79, s40, v19
    v_mfma_f32_16x16x32_bf16 v[252:255], a[172:175], v[196:199], v[252:255]
    v_perm_b32 v245, v57, v56, v245
    v_perm_b32 v247, v57, v56, v247
    v_perm_b32 v66, v82, v80, s42
    v_mfma_f32_16x16x32_bf16 v[252:255], a[176:179], v[204:207], v[252:255]
    v_perm_b32 v63, v82, v80, s43
    v_perm_b32 v67, v82, v80, s43
    v_mfma_f32_16x16x32_bf16 v[252:255], a[180:183], v[212:215], v[252:255]
    ds_read_b128 a[120:123], v34 offset:0
    ds_read_b128 a[124:127], v35 offset:0
    ds_read_b128 a[128:131], v36 offset:0
    ds_read_b128 a[132:135], v37 offset:0
    ds_read_b128 a[136:139], v34 offset:4096
    ds_read_b128 a[140:143], v35 offset:4096
    ds_read_b128 a[144:147], v36 offset:4096
    ds_read_b128 a[148:151], v37 offset:4096
    ds_read_b128 a[152:155], v34 offset:8192
    ds_read_b128 a[156:159], v35 offset:8192
    ds_read_b128 a[160:163], v36 offset:8192
    ds_read_b128 a[164:167], v37 offset:8192
    s_waitcnt lgkmcnt(0)
    v_mfma_f32_16x16x32_bf16 a[0:3], a[120:123], v[216:219], a[0:3]
    s_nop 0
    v_and_b32 v84, 0xffff0000, v52
    v_and_b32 v85, 0xffff0000, v53
    v_mfma_f32_16x16x32_bf16 a[0:3], a[124:127], v[224:227], a[0:3]
    s_waitcnt vmcnt(14)
    ds_read_b128 a[168:171], v34 offset:12288
    v_lshrrev_b64 v[70:71], 2, v[46:47]
    v_mfma_f32_16x16x32_bf16 a[0:3], a[128:131], v[232:235], a[0:3]
    s_nop 0
    v_perm_b32 v72, v70, v46, s36
    v_perm_b32 v73, v70, v46, s37
    v_mfma_f32_16x16x32_bf16 a[0:3], a[132:135], v[240:243], a[0:3]
    ds_read_b128 a[172:175], v35 offset:12288
    v_and_or_b32 v88, v72, s40, v19
    v_mfma_f32_16x16x32_bf16 a[4:7], a[120:123], v[220:223], a[4:7]
    v_lshrrev_b64 v[74:75], 4, v[72:73]
    v_and_or_b32 v90, v73, s40, v19
    v_mfma_f32_16x16x32_bf16 a[4:7], a[124:127], v[228:231], a[4:7]
    ds_read_b128 a[176:179], v36 offset:12288
    v_perm_b32 v88, v59, v58, v88
    v_and_or_b32 v89, v74, s40, v19
    v_mfma_f32_16x16x32_bf16 a[4:7], a[128:131], v[236:239], a[4:7]
    v_perm_b32 v90, v59, v58, v90
    v_and_or_b32 v91, v75, s40, v19
    v_mfma_f32_16x16x32_bf16 a[4:7], a[132:135], v[244:247], a[4:7]
    ds_read_b128 a[180:183], v37 offset:12288
    v_perm_b32 v89, v59, v58, v89
    v_mfma_f32_16x16x32_bf16 a[8:11], a[136:139], v[216:219], a[8:11]
    v_perm_b32 v91, v59, v58, v91
    v_perm_b32 v76, v71, v47, s36
    v_mfma_f32_16x16x32_bf16 a[8:11], a[140:143], v[224:227], a[8:11]
    ds_read_b128 a[120:123], v34 offset:16384
    v_perm_b32 v77, v71, v47, s37
    v_mfma_f32_16x16x32_bf16 a[8:11], a[144:147], v[232:235], a[8:11]
    v_and_or_b32 v92, v76, s40, v19
    v_lshrrev_b64 v[78:79], 4, v[76:77]
    v_mfma_f32_16x16x32_bf16 a[8:11], a[148:151], v[240:243], a[8:11]
    ds_read_b128 a[124:127], v35 offset:16384
    v_and_or_b32 v94, v77, s40, v19
    v_mfma_f32_16x16x32_bf16 a[12:15], a[136:139], v[220:223], a[12:15]
    v_perm_b32 v92, v61, v60, v92
    v_and_or_b32 v93, v78, s40, v19
    v_perm_b32 v94, v61, v60, v94
    v_mfma_f32_16x16x32_bf16 a[12:15], a[140:143], v[228:231], a[12:15]
    ds_read_b128 a[128:131], v36 offset:16384
    v_and_or_b32 v95, v79, s40, v19
    v_mfma_f32_16x16x32_bf16 a[12:15], a[144:147], v[236:239], a[12:15]
    v_perm_b32 v93, v61, v60, v93
    v_perm_b32 v95, v61, v60, v95
    v_mfma_f32_16x16x32_bf16 a[12:15], a[148:151], v[244:247], a[12:15]
    ds_read_b128 a[132:135], v37 offset:16384
    v_mul_f32_e64 v80, v85, v84
    v_mfma_f32_16x16x32_bf16 a[16:19], a[152:155], v[216:219], a[16:19]
    v_sub_f32_e64 v81, v84, v80
    v_fma_f32 v82, 2.0, v84, -v80
    v_mfma_f32_16x16x32_bf16 a[16:19], a[156:159], v[224:227], a[16:19]
    ds_read_b128 a[136:139], v34 offset:20480
    v_fma_f32 v83, s41, v84, -v80
    v_mfma_f32_16x16x32_bf16 a[16:19], a[160:163], v[232:235], a[16:19]
    buffer_load_dwordx2 v[40:41], v17, s[20:23], 0 offen
    v_perm_b32 v72, v70, v46, s38
    v_mfma_f32_16x16x32_bf16 a[16:19], a[164:167], v[240:243], a[16:19]
    ds_read_b128 a[140:143], v35 offset:20480
    v_perm_b32 v73, v70, v46, s39
    v_mfma_f32_16x16x32_bf16 a[20:23], a[152:155], v[220:223], a[20:23]
    v_and_or_b32 v96, v72, s40, v19
    v_lshrrev_b64 v[74:75], 4, v[72:73]
    v_and_or_b32 v98, v73, s40, v19
    v_mfma_f32_16x16x32_bf16 a[20:23], a[156:159], v[228:231], a[20:23]
    ds_read_b128 a[144:147], v36 offset:20480
    v_perm_b32 v96, v59, v58, v96
    v_mfma_f32_16x16x32_bf16 a[20:23], a[160:163], v[236:239], a[20:23]
    v_and_or_b32 v97, v74, s40, v19
    v_perm_b32 v98, v59, v58, v98
    v_mfma_f32_16x16x32_bf16 a[20:23], a[164:167], v[244:247], a[20:23]
    s_waitcnt lgkmcnt(7)
    ds_read_b128 a[148:151], v37 offset:20480
    v_and_or_b32 v99, v75, s40, v19
    v_mfma_f32_16x16x32_bf16 a[24:27], a[168:171], v[216:219], a[24:27]
    s_nop 0
    v_perm_b32 v97, v59, v58, v97
    v_perm_b32 v99, v59, v58, v99
    v_mfma_f32_16x16x32_bf16 a[24:27], a[172:175], v[224:227], a[24:27]
    ds_read_b128 a[152:155], v34 offset:24576
    v_perm_b32 v76, v71, v47, s38
    v_mfma_f32_16x16x32_bf16 a[24:27], a[176:179], v[232:235], a[24:27]
    v_perm_b32 v77, v71, v47, s39
    v_and_or_b32 v100, v76, s40, v19
    v_mfma_f32_16x16x32_bf16 a[24:27], a[180:183], v[240:243], a[24:27]
    ds_read_b128 a[156:159], v35 offset:24576
    v_lshrrev_b64 v[78:79], 4, v[76:77]
    v_mfma_f32_16x16x32_bf16 a[28:31], a[168:171], v[220:223], a[28:31]
    v_and_or_b32 v102, v77, s40, v19
    v_perm_b32 v100, v61, v60, v100
    v_and_or_b32 v101, v78, s40, v19
    v_mfma_f32_16x16x32_bf16 a[28:31], a[172:175], v[228:231], a[28:31]
    ds_read_b128 a[160:163], v36 offset:24576
    v_perm_b32 v102, v61, v60, v102
    v_mfma_f32_16x16x32_bf16 a[28:31], a[176:179], v[236:239], a[28:31]
    v_and_or_b32 v103, v79, s40, v19
    v_perm_b32 v101, v61, v60, v101
    v_mfma_f32_16x16x32_bf16 a[28:31], a[180:183], v[244:247], a[28:31]
    s_waitcnt lgkmcnt(7)
    ds_read_b128 a[164:167], v37 offset:24576
    v_perm_b32 v103, v61, v60, v103
    v_mfma_f32_16x16x32_bf16 a[32:35], a[120:123], v[216:219], a[32:35]
    s_nop 0
    v_cvt_pk_bf16_f32 v80, -v80, v81
    v_cvt_pk_bf16_f32 v82, v82, v83
    v_mfma_f32_16x16x32_bf16 a[32:35], a[124:127], v[224:227], a[32:35]
    ds_read_b128 a[168:171], v34 offset:28672
    v_perm_b32 v64, v82, v80, s42
    v_mfma_f32_16x16x32_bf16 a[32:35], a[128:131], v[232:235], a[32:35]
    s_waitcnt vmcnt(5)
    v_perm_b32 v68, v82, v80, s42
    v_perm_b32 v65, v82, v80, s43
    v_lshrrev_b64 v[70:71], 2, v[48:49]
    v_mfma_f32_16x16x32_bf16 a[32:35], a[132:135], v[240:243], a[32:35]
    s_nop 0
    ds_read_b128 a[172:175], v35 offset:28672
    v_perm_b32 v72, v70, v48, s36
    v_mfma_f32_16x16x32_bf16 a[36:39], a[120:123], v[220:223], a[36:39]
    v_perm_b32 v73, v70, v48, s37
    v_and_or_b32 v104, v72, s40, v19
    v_mfma_f32_16x16x32_bf16 a[36:39], a[124:127], v[228:231], a[36:39]
    ds_read_b128 a[176:179], v36 offset:28672
    v_lshrrev_b64 v[74:75], 4, v[72:73]
    v_mfma_f32_16x16x32_bf16 a[36:39], a[128:131], v[236:239], a[36:39]
    v_and_or_b32 v106, v73, s40, v19
    v_perm_b32 v104, v59, v58, v104
    v_mfma_f32_16x16x32_bf16 a[36:39], a[132:135], v[244:247], a[36:39]
    s_waitcnt lgkmcnt(7)
    ds_read_b128 a[180:183], v37 offset:28672
    v_and_or_b32 v105, v74, s40, v19
    v_mfma_f32_16x16x32_bf16 a[40:43], a[136:139], v[216:219], a[40:43]
    s_barrier
    v_mfma_f32_16x16x32_bf16 a[40:43], a[140:143], v[224:227], a[40:43]
    ds_read_b128 a[120:123], v26 offset:0
    v_perm_b32 v106, v59, v58, v106
    v_mfma_f32_16x16x32_bf16 a[40:43], a[144:147], v[232:235], a[40:43]
    v_and_or_b32 v107, v75, s40, v19
    v_perm_b32 v105, v59, v58, v105
    v_mfma_f32_16x16x32_bf16 a[40:43], a[148:151], v[240:243], a[40:43]
    ds_read_b128 a[124:127], v27 offset:0
    v_perm_b32 v107, v59, v58, v107
    v_perm_b32 v76, v71, v49, s36
    v_mfma_f32_16x16x32_bf16 a[44:47], a[136:139], v[220:223], a[44:47]
    v_perm_b32 v77, v71, v49, s37
    v_and_or_b32 v108, v76, s40, v19
    v_mfma_f32_16x16x32_bf16 a[44:47], a[140:143], v[228:231], a[44:47]
    s_mov_b64 s[20:21], s[78:79]
    ds_read_b128 a[128:131], v28 offset:0
    v_lshrrev_b64 v[78:79], 4, v[76:77]
    v_mfma_f32_16x16x32_bf16 a[44:47], a[144:147], v[236:239], a[44:47]
    buffer_load_dwordx2 v[42:43], v16, s[20:23], 0 offen
    v_and_or_b32 v110, v77, s40, v19
    v_mfma_f32_16x16x32_bf16 a[44:47], a[148:151], v[244:247], a[44:47]
    s_waitcnt lgkmcnt(7)
    ds_read_b128 a[132:135], v29 offset:0
    v_perm_b32 v108, v61, v60, v108
    v_mfma_f32_16x16x32_bf16 a[48:51], a[152:155], v[216:219], a[48:51]
    v_and_or_b32 v109, v78, s40, v19
    v_perm_b32 v110, v61, v60, v110
    v_mfma_f32_16x16x32_bf16 a[48:51], a[156:159], v[224:227], a[48:51]
    ds_read_b128 a[136:139], v26 offset:4096
    v_and_or_b32 v111, v79, s40, v19
    v_mfma_f32_16x16x32_bf16 a[48:51], a[160:163], v[232:235], a[48:51]
    v_perm_b32 v109, v61, v60, v109
    v_perm_b32 v111, v61, v60, v111
    v_mfma_f32_16x16x32_bf16 a[48:51], a[164:167], v[240:243], a[48:51]
    ds_read_b128 a[140:143], v27 offset:4096
    v_perm_b32 v69, v82, v80, s43
    v_mfma_f32_16x16x32_bf16 a[52:55], a[152:155], v[220:223], a[52:55]
    v_permlane16_swap_b32_e64 v62, v66
    v_mfma_f32_16x16x32_bf16 a[52:55], a[156:159], v[228:231], a[52:55]
    ds_read_b128 a[144:147], v28 offset:4096
    v_perm_b32 v72, v70, v48, s38
    v_mfma_f32_16x16x32_bf16 a[52:55], a[160:163], v[236:239], a[52:55]
    v_permlane16_swap_b32_e64 v63, v67
    v_mfma_f32_16x16x32_bf16 a[52:55], a[164:167], v[244:247], a[52:55]
    s_waitcnt lgkmcnt(7)
    ds_read_b128 a[148:151], v29 offset:4096
    v_perm_b32 v73, v70, v48, s39
    v_mfma_f32_16x16x32_bf16 v[248:251], a[168:171], v[216:219], v[248:251]
    s_nop 0
    v_permlane16_swap_b32_e64 v64, v68
    v_permlane16_swap_b32_e64 v65, v69
    v_mfma_f32_16x16x32_bf16 v[248:251], a[172:175], v[224:227], v[248:251]
    ds_read_b128 a[152:155], v26 offset:8192
    v_and_or_b32 v112, v72, s40, v19
    v_mfma_f32_16x16x32_bf16 v[248:251], a[176:179], v[232:235], v[248:251]
    v_lshrrev_b64 v[74:75], 4, v[72:73]
    v_and_or_b32 v114, v73, s40, v19
    v_mfma_f32_16x16x32_bf16 v[248:251], a[180:183], v[240:243], v[248:251]
    ds_read_b128 a[156:159], v27 offset:8192
    v_perm_b32 v112, v59, v58, v112
    v_mfma_f32_16x16x32_bf16 v[252:255], a[168:171], v[220:223], v[252:255]
    v_and_or_b32 v113, v74, s40, v19
    v_perm_b32 v114, v59, v58, v114
    v_mfma_f32_16x16x32_bf16 v[252:255], a[172:175], v[228:231], v[252:255]
    ds_read_b128 a[160:163], v28 offset:8192
    v_and_or_b32 v115, v75, s40, v19
    v_mfma_f32_16x16x32_bf16 v[252:255], a[176:179], v[236:239], v[252:255]
    v_perm_b32 v113, v59, v58, v113
    v_perm_b32 v115, v59, v58, v115
    v_mfma_f32_16x16x32_bf16 v[252:255], a[180:183], v[244:247], v[252:255]
    s_waitcnt lgkmcnt(7)
    ds_read_b128 a[164:167], v29 offset:8192
    v_perm_b32 v76, v71, v49, s38
    v_mfma_f32_16x16x32_bf16 a[0:3], a[120:123], v[88:91], a[0:3]
    s_nop 0
    v_perm_b32 v77, v71, v49, s39
    v_and_or_b32 v116, v76, s40, v19
    v_mfma_f32_16x16x32_bf16 a[0:3], a[124:127], v[96:99], a[0:3]
    ds_read_b128 a[168:171], v26 offset:12288
    v_lshrrev_b64 v[78:79], 4, v[76:77]
    v_and_or_b32 v118, v77, s40, v19
    v_mfma_f32_16x16x32_bf16 a[0:3], a[128:131], v[104:107], a[0:3]
    v_perm_b32 v116, v61, v60, v116
    v_and_or_b32 v117, v78, s40, v19
    v_mfma_f32_16x16x32_bf16 a[0:3], a[132:135], v[112:115], a[0:3]
    ds_read_b128 a[172:175], v27 offset:12288
    v_perm_b32 v118, v61, v60, v118
    v_mfma_f32_16x16x32_bf16 a[4:7], a[120:123], v[92:95], a[4:7]
    v_and_or_b32 v119, v79, s40, v19
    v_perm_b32 v117, v61, v60, v117
    v_mfma_f32_16x16x32_bf16 a[4:7], a[124:127], v[100:103], a[4:7]
    ds_read_b128 a[176:179], v28 offset:12288
    v_perm_b32 v119, v61, v60, v119
    v_mfma_f32_16x16x32_bf16 a[4:7], a[128:131], v[108:111], a[4:7]
    s_waitcnt vmcnt(2)
    v_lshrrev_b64 v[70:71], 2, v[38:39]
    v_perm_b32 v72, v70, v38, s36
    v_mfma_f32_16x16x32_bf16 a[4:7], a[132:135], v[116:119], a[4:7]
    s_waitcnt lgkmcnt(7)
    ds_read_b128 a[180:183], v29 offset:12288
    v_perm_b32 v73, v70, v38, s37
    v_mfma_f32_16x16x32_bf16 a[8:11], a[136:139], v[88:91], a[8:11]
    v_and_or_b32 v120, v72, s40, v19
    v_mfma_f32_16x16x32_bf16 a[8:11], a[140:143], v[96:99], a[8:11]
    ds_read_b128 a[120:123], v26 offset:16384
    v_lshrrev_b64 v[74:75], 4, v[72:73]
    v_mfma_f32_16x16x32_bf16 a[8:11], a[144:147], v[104:107], a[8:11]
    buffer_load_dwordx2 v[44:45], v17, s[20:23], 0 offen
    v_and_or_b32 v122, v73, s40, v19
    v_mfma_f32_16x16x32_bf16 a[8:11], a[148:151], v[112:115], a[8:11]
    ds_read_b128 a[124:127], v27 offset:16384
    v_perm_b32 v120, v63, v62, v120
    v_mfma_f32_16x16x32_bf16 a[12:15], a[136:139], v[92:95], a[12:15]
    v_and_or_b32 v121, v74, s40, v19
    v_perm_b32 v122, v63, v62, v122
    v_mfma_f32_16x16x32_bf16 a[12:15], a[140:143], v[100:103], a[12:15]
    ds_read_b128 a[128:131], v28 offset:16384
    v_and_or_b32 v123, v75, s40, v19
    v_mfma_f32_16x16x32_bf16 a[12:15], a[144:147], v[108:111], a[12:15]
    v_perm_b32 v121, v63, v62, v121
    v_perm_b32 v123, v63, v62, v123
    v_mfma_f32_16x16x32_bf16 a[12:15], a[148:151], v[116:119], a[12:15]
    s_waitcnt lgkmcnt(7)
    ds_read_b128 a[132:135], v29 offset:16384
    v_perm_b32 v76, v71, v39, s36
    v_mfma_f32_16x16x32_bf16 a[16:19], a[152:155], v[88:91], a[16:19]
    s_nop 0
    v_perm_b32 v77, v71, v39, s37
    v_and_or_b32 v124, v76, s40, v19
    v_mfma_f32_16x16x32_bf16 a[16:19], a[156:159], v[96:99], a[16:19]
    ds_read_b128 a[136:139], v26 offset:20480
    v_lshrrev_b64 v[78:79], 4, v[76:77]
    v_mfma_f32_16x16x32_bf16 a[16:19], a[160:163], v[104:107], a[16:19]
    v_and_or_b32 v126, v77, s40, v19
    v_perm_b32 v124, v65, v64, v124
    v_mfma_f32_16x16x32_bf16 a[16:19], a[164:167], v[112:115], a[16:19]
    ds_read_b128 a[140:143], v27 offset:20480
    v_and_or_b32 v125, v78, s40, v19
    v_mfma_f32_16x16x32_bf16 a[20:23], a[152:155], v[92:95], a[20:23]
    v_perm_b32 v126, v65, v64, v126
    v_and_or_b32 v127, v79, s40, v19
    v_mfma_f32_16x16x32_bf16 a[20:23], a[156:159], v[100:103], a[20:23]
    ds_read_b128 a[144:147], v28 offset:20480
    v_perm_b32 v125, v65, v64, v125
    v_mfma_f32_16x16x32_bf16 a[20:23], a[160:163], v[108:111], a[20:23]
    v_perm_b32 v127, v65, v64, v127
    v_perm_b32 v72, v70, v38, s38
    v_mfma_f32_16x16x32_bf16 a[20:23], a[164:167], v[116:119], a[20:23]
    s_waitcnt lgkmcnt(7)
    ds_read_b128 a[148:151], v29 offset:20480
    v_perm_b32 v73, v70, v38, s39
    v_mfma_f32_16x16x32_bf16 a[24:27], a[168:171], v[88:91], a[24:27]
    s_barrier
    v_mfma_f32_16x16x32_bf16 a[24:27], a[172:175], v[96:99], a[24:27]
    ds_read_b128 a[152:155], v26 offset:24576
    v_and_or_b32 v128, v72, s40, v19
    v_mfma_f32_16x16x32_bf16 a[24:27], a[176:179], v[104:107], a[24:27]
    v_lshrrev_b64 v[74:75], 4, v[72:73]
    v_and_or_b32 v130, v73, s40, v19
    v_mfma_f32_16x16x32_bf16 a[24:27], a[180:183], v[112:115], a[24:27]
    ds_read_b128 a[156:159], v27 offset:24576
    v_perm_b32 v128, v63, v62, v128
    v_mfma_f32_16x16x32_bf16 a[28:31], a[168:171], v[92:95], a[28:31]
    v_and_or_b32 v129, v74, s40, v19
    v_perm_b32 v130, v63, v62, v130
    v_mfma_f32_16x16x32_bf16 a[28:31], a[172:175], v[100:103], a[28:31]
    ds_read_b128 a[160:163], v28 offset:24576
    v_and_or_b32 v131, v75, s40, v19
    v_mfma_f32_16x16x32_bf16 a[28:31], a[176:179], v[108:111], a[28:31]
    v_perm_b32 v129, v63, v62, v129
    v_perm_b32 v131, v63, v62, v131
    v_mfma_f32_16x16x32_bf16 a[28:31], a[180:183], v[116:119], a[28:31]
    s_waitcnt lgkmcnt(7)
    ds_read_b128 a[164:167], v29 offset:24576
    v_perm_b32 v76, v71, v39, s38
    v_mfma_f32_16x16x32_bf16 a[32:35], a[120:123], v[88:91], a[32:35]
    s_nop 0
    v_perm_b32 v77, v71, v39, s39
    v_and_or_b32 v132, v76, s40, v19
    v_mfma_f32_16x16x32_bf16 a[32:35], a[124:127], v[96:99], a[32:35]
    ds_read_b128 a[168:171], v26 offset:28672
    v_lshrrev_b64 v[78:79], 4, v[76:77]
    v_mfma_f32_16x16x32_bf16 a[32:35], a[128:131], v[104:107], a[32:35]
    v_and_or_b32 v134, v77, s40, v19
    v_perm_b32 v132, v65, v64, v132
    v_mfma_f32_16x16x32_bf16 a[32:35], a[132:135], v[112:115], a[32:35]
    ds_read_b128 a[172:175], v27 offset:28672
    v_and_or_b32 v133, v78, s40, v19
    v_mfma_f32_16x16x32_bf16 a[36:39], a[120:123], v[92:95], a[36:39]
    v_perm_b32 v134, v65, v64, v134
    v_mfma_f32_16x16x32_bf16 a[36:39], a[124:127], v[100:103], a[36:39]
    ds_read_b128 a[176:179], v28 offset:28672
    v_and_or_b32 v135, v79, s40, v19
    v_mfma_f32_16x16x32_bf16 a[36:39], a[128:131], v[108:111], a[36:39]
    v_perm_b32 v133, v65, v64, v133
    v_perm_b32 v135, v65, v64, v135
    v_mfma_f32_16x16x32_bf16 a[36:39], a[132:135], v[116:119], a[36:39]
    s_waitcnt vmcnt(2) lgkmcnt(7)
    ds_read_b128 a[180:183], v29 offset:28672
    v_lshrrev_b64 v[70:71], 2, v[40:41]
    v_mfma_f32_16x16x32_bf16 a[40:43], a[136:139], v[88:91], a[40:43]
    s_nop 0
    v_perm_b32 v72, v70, v40, s36
    v_perm_b32 v73, v70, v40, s37
    v_mfma_f32_16x16x32_bf16 a[40:43], a[140:143], v[96:99], a[40:43]
    ds_read_b128 a[120:123], v26 offset:32768
    v_and_or_b32 v136, v72, s40, v19
    v_mfma_f32_16x16x32_bf16 a[40:43], a[144:147], v[104:107], a[40:43]
    v_lshrrev_b64 v[74:75], 4, v[72:73]
    v_and_or_b32 v138, v73, s40, v19
    v_mfma_f32_16x16x32_bf16 a[40:43], a[148:151], v[112:115], a[40:43]
L_padB2:
    s_cbranch_vccnz L_backB
    s_nop 0
    ds_read_b128 a[124:127], v27 offset:32768
    v_perm_b32 v136, v63, v62, v136
    v_mfma_f32_16x16x32_bf16 a[44:47], a[136:139], v[92:95], a[44:47]
    v_and_or_b32 v137, v74, s40, v19
    v_perm_b32 v138, v63, v62, v138
    v_mfma_f32_16x16x32_bf16 a[44:47], a[140:143], v[100:103], a[44:47]
    ds_read_b128 a[128:131], v28 offset:32768
    v_and_or_b32 v139, v75, s40, v19
    v_mfma_f32_16x16x32_bf16 a[44:47], a[144:147], v[108:111], a[44:47]
    v_perm_b32 v137, v63, v62, v137
    v_perm_b32 v139, v63, v62, v139
    v_mfma_f32_16x16x32_bf16 a[44:47], a[148:151], v[116:119], a[44:47]
    s_waitcnt lgkmcnt(7)
    ds_read_b128 a[132:135], v29 offset:32768
    v_perm_b32 v76, v71, v41, s36
    v_mfma_f32_16x16x32_bf16 a[48:51], a[152:155], v[88:91], a[48:51]
    s_nop 0
    v_perm_b32 v77, v71, v41, s37
    v_and_or_b32 v140, v76, s40, v19
    v_mfma_f32_16x16x32_bf16 a[48:51], a[156:159], v[96:99], a[48:51]
    ds_read_b128 a[136:139], v26 offset:36864
    v_lshrrev_b64 v[78:79], 4, v[76:77]
    v_mfma_f32_16x16x32_bf16 a[48:51], a[160:163], v[104:107], a[48:51]
    v_and_or_b32 v142, v77, s40, v19
    v_perm_b32 v140, v65, v64, v140
    v_mfma_f32_16x16x32_bf16 a[48:51], a[164:167], v[112:115], a[48:51]
    ds_read_b128 a[140:143], v27 offset:36864
    v_and_or_b32 v141, v78, s40, v19
    v_mfma_f32_16x16x32_bf16 a[52:55], a[152:155], v[92:95], a[52:55]
    v_perm_b32 v142, v65, v64, v142
    v_and_or_b32 v143, v79, s40, v19
    v_mfma_f32_16x16x32_bf16 a[52:55], a[156:159], v[100:103], a[52:55]
    ds_read_b128 a[144:147], v28 offset:36864
    v_perm_b32 v141, v65, v64, v141
    v_mfma_f32_16x16x32_bf16 a[52:55], a[160:163], v[108:111], a[52:55]
    v_perm_b32 v143, v65, v64, v143
    v_perm_b32 v72, v70, v40, s38
    v_mfma_f32_16x16x32_bf16 a[52:55], a[164:167], v[116:119], a[52:55]
    s_waitcnt lgkmcnt(7)
    ds_read_b128 a[148:151], v29 offset:36864
    v_perm_b32 v73, v70, v40, s39
    v_mfma_f32_16x16x32_bf16 v[248:251], a[168:171], v[88:91], v[248:251]
    s_nop 0
    v_and_or_b32 v144, v72, s40, v19
    v_lshrrev_b64 v[74:75], 4, v[72:73]
    v_mfma_f32_16x16x32_bf16 v[248:251], a[172:175], v[96:99], v[248:251]
    ds_read_b128 a[152:155], v26 offset:40960
    v_and_or_b32 v146, v73, s40, v19
    v_mfma_f32_16x16x32_bf16 v[248:251], a[176:179], v[104:107], v[248:251]
    v_perm_b32 v144, v63, v62, v144
    v_and_or_b32 v145, v74, s40, v19
    v_mfma_f32_16x16x32_bf16 v[248:251], a[180:183], v[112:115], v[248:251]
    ds_read_b128 a[156:159], v27 offset:40960
    v_perm_b32 v146, v63, v62, v146
    v_mfma_f32_16x16x32_bf16 v[252:255], a[168:171], v[92:95], v[252:255]
    v_and_or_b32 v147, v75, s40, v19
    v_perm_b32 v145, v63, v62, v145
    v_mfma_f32_16x16x32_bf16 v[252:255], a[172:175], v[100:103], v[252:255]
    ds_read_b128 a[160:163], v28 offset:40960
    v_perm_b32 v147, v63, v62, v147
    v_mfma_f32_16x16x32_bf16 v[252:255], a[176:179], v[108:111], v[252:255]
    v_perm_b32 v76, v71, v41, s38
    v_perm_b32 v77, v71, v41, s39
    v_mfma_f32_16x16x32_bf16 v[252:255], a[180:183], v[116:119], v[252:255]
    s_waitcnt lgkmcnt(7)
    ds_read_b128 a[164:167], v29 offset:40960
    v_mfma_f32_16x16x32_bf16 a[0:3], a[120:123], v[120:123], a[0:3]
    s_nop 0
    v_and_or_b32 v148, v76, s40, v19
    v_lshrrev_b64 v[78:79], 4, v[76:77]
    v_mfma_f32_16x16x32_bf16 a[0:3], a[124:127], v[128:131], a[0:3]
    ds_read_b128 a[168:171], v26 offset:45056
    v_and_or_b32 v150, v77, s40, v19
    v_mfma_f32_16x16x32_bf16 a[0:3], a[128:131], v[136:139], a[0:3]
    v_perm_b32 v148, v65, v64, v148
    v_and_or_b32 v149, v78, s40, v19
    v_mfma_f32_16x16x32_bf16 a[0:3], a[132:135], v[144:147], a[0:3]
    ds_read_b128 a[172:175], v27 offset:45056
    v_perm_b32 v150, v65, v64, v150
    v_mfma_f32_16x16x32_bf16 a[4:7], a[120:123], v[124:127], a[4:7]
    v_and_or_b32 v151, v79, s40, v19
    v_perm_b32 v149, v65, v64, v149
    v_mfma_f32_16x16x32_bf16 a[4:7], a[124:127], v[132:135], a[4:7]
    ds_read_b128 a[176:179], v28 offset:45056
    v_perm_b32 v151, v65, v64, v151
    v_mfma_f32_16x16x32_bf16 a[4:7], a[128:131], v[140:143], a[4:7]
    s_waitcnt vmcnt(1)
    v_lshrrev_b64 v[70:71], 2, v[42:43]
    v_perm_b32 v72, v70, v42, s36
    v_mfma_f32_16x16x32_bf16 a[4:7], a[132:135], v[148:151], a[4:7]
    s_waitcnt lgkmcnt(7)
    ds_read_b128 a[180:183], v29 offset:45056
    v_perm_b32 v73, v70, v42, s37
    v_mfma_f32_16x16x32_bf16 a[8:11], a[136:139], v[120:123], a[8:11]
    s_barrier
    v_mfma_f32_16x16x32_bf16 a[8:11], a[140:143], v[128:131], a[8:11]
    s_nop 0
    ds_read_b128 a[120:123], v26 offset:49152
    v_and_or_b32 v152, v72, s40, v19
    v_mfma_f32_16x16x32_bf16 a[8:11], a[144:147], v[136:139], a[8:11]
    v_lshrrev_b64 v[74:75], 4, v[72:73]
    v_and_or_b32 v154, v73, s40, v19
    v_mfma_f32_16x16x32_bf16 a[8:11], a[148:151], v[144:147], a[8:11]
    ds_read_b128 a[124:127], v27 offset:49152
    v_perm_b32 v152, v67, v66, v152
    v_mfma_f32_16x16x32_bf16 a[12:15], a[136:139], v[124:127], a[12:15]
    v_and_or_b32 v153, v74, s40, v19
    v_perm_b32 v154, v67, v66, v154
    v_mfma_f32_16x16x32_bf16 a[12:15], a[140:143], v[132:135], a[12:15]
    ds_read_b128 a[128:131], v28 offset:49152
    v_and_or_b32 v155, v75, s40, v19
    v_mfma_f32_16x16x32_bf16 a[12:15], a[144:147], v[140:143], a[12:15]
    v_perm_b32 v153, v67, v66, v153
    v_perm_b32 v155, v67, v66, v155
    v_mfma_f32_16x16x32_bf16 a[12:15], a[148:151], v[148:151], a[12:15]
    s_waitcnt lgkmcnt(7)
    ds_read_b128 a[132:135], v29 offset:49152
    v_perm_b32 v76, v71, v43, s36
    v_mfma_f32_16x16x32_bf16 a[16:19], a[152:155], v[120:123], a[16:19]
    s_nop 0
    v_perm_b32 v77, v71, v43, s37
    v_and_or_b32 v156, v76, s40, v19
    v_mfma_f32_16x16x32_bf16 a[16:19], a[156:159], v[128:131], a[16:19]
    ds_read_b128 a[136:139], v26 offset:53248
    v_lshrrev_b64 v[78:79], 4, v[76:77]
    v_mfma_f32_16x16x32_bf16 a[16:19], a[160:163], v[136:139], a[16:19]
    v_and_or_b32 v158, v77, s40, v19
    v_perm_b32 v156, v69, v68, v156
    v_mfma_f32_16x16x32_bf16 a[16:19], a[164:167], v[144:147], a[16:19]
    ds_read_b128 a[140:143], v27 offset:53248
    v_and_or_b32 v157, v78, s40, v19
    v_mfma_f32_16x16x32_bf16 a[20:23], a[152:155], v[124:127], a[20:23]
    v_perm_b32 v158, v69, v68, v158
    v_and_or_b32 v159, v79, s40, v19
    v_mfma_f32_16x16x32_bf16 a[20:23], a[156:159], v[132:135], a[20:23]
    ds_read_b128 a[144:147], v28 offset:53248
    v_perm_b32 v157, v69, v68, v157
    v_mfma_f32_16x16x32_bf16 a[20:23], a[160:163], v[140:143], a[20:23]
    v_perm_b32 v159, v69, v68, v159
    v_perm_b32 v72, v70, v42, s38
    v_mfma_f32_16x16x32_bf16 a[20:23], a[164:167], v[148:151], a[20:23]
    s_waitcnt lgkmcnt(7)
    ds_read_b128 a[148:151], v29 offset:53248
    v_perm_b32 v73, v70, v42, s39
    v_mfma_f32_16x16x32_bf16 a[24:27], a[168:171], v[120:123], a[24:27]
    s_nop 0
    v_and_or_b32 v160, v72, s40, v19
    v_lshrrev_b64 v[74:75], 4, v[72:73]
    v_mfma_f32_16x16x32_bf16 a[24:27], a[172:175], v[128:131], a[24:27]
    ds_read_b128 a[152:155], v26 offset:57344
    v_and_or_b32 v162, v73, s40, v19
    v_mfma_f32_16x16x32_bf16 a[24:27], a[176:179], v[136:139], a[24:27]
    v_perm_b32 v160, v67, v66, v160
    v_and_or_b32 v161, v74, s40, v19
    v_mfma_f32_16x16x32_bf16 a[24:27], a[180:183], v[144:147], a[24:27]
    ds_read_b128 a[156:159], v27 offset:57344
    v_perm_b32 v162, v67, v66, v162
    v_mfma_f32_16x16x32_bf16 a[28:31], a[168:171], v[124:127], a[28:31]
    v_and_or_b32 v163, v75, s40, v19
    v_perm_b32 v161, v67, v66, v161
    v_mfma_f32_16x16x32_bf16 a[28:31], a[172:175], v[132:135], a[28:31]
    ds_read_b128 a[160:163], v28 offset:57344
    v_perm_b32 v163, v67, v66, v163
    v_mfma_f32_16x16x32_bf16 a[28:31], a[176:179], v[140:143], a[28:31]
    v_perm_b32 v76, v71, v43, s38
    v_perm_b32 v77, v71, v43, s39
    v_mfma_f32_16x16x32_bf16 a[28:31], a[180:183], v[148:151], a[28:31]
    s_waitcnt lgkmcnt(7)
    ds_read_b128 a[164:167], v29 offset:57344
    v_mfma_f32_16x16x32_bf16 a[32:35], a[120:123], v[120:123], a[32:35]
    s_nop 0
    v_and_or_b32 v164, v76, s40, v19
    v_lshrrev_b64 v[78:79], 4, v[76:77]
    v_mfma_f32_16x16x32_bf16 a[32:35], a[124:127], v[128:131], a[32:35]
    ds_read_b128 a[168:171], v26 offset:61440
    v_and_or_b32 v166, v77, s40, v19
    v_mfma_f32_16x16x32_bf16 a[32:35], a[128:131], v[136:139], a[32:35]
    v_perm_b32 v164, v69, v68, v164
    v_and_or_b32 v165, v78, s40, v19
    v_mfma_f32_16x16x32_bf16 a[32:35], a[132:135], v[144:147], a[32:35]
    ds_read_b128 a[172:175], v27 offset:61440
    v_perm_b32 v166, v69, v68, v166
    v_mfma_f32_16x16x32_bf16 a[36:39], a[120:123], v[124:127], a[36:39]
    v_and_or_b32 v167, v79, s40, v19
    v_perm_b32 v165, v69, v68, v165
    v_mfma_f32_16x16x32_bf16 a[36:39], a[124:127], v[132:135], a[36:39]
    ds_read_b128 a[176:179], v28 offset:61440
    v_perm_b32 v167, v69, v68, v167
    v_mfma_f32_16x16x32_bf16 a[36:39], a[128:131], v[140:143], a[36:39]
    s_waitcnt vmcnt(0)
    v_lshrrev_b64 v[70:71], 2, v[44:45]
    v_perm_b32 v72, v70, v44, s36
    v_mfma_f32_16x16x32_bf16 a[36:39], a[132:135], v[148:151], a[36:39]
    s_waitcnt lgkmcnt(7)
    ds_read_b128 a[180:183], v29 offset:61440
    v_perm_b32 v73, v70, v44, s37
    v_mfma_f32_16x16x32_bf16 a[40:43], a[136:139], v[120:123], a[40:43]
    v_and_or_b32 v168, v72, s40, v19
    v_lshrrev_b64 v[74:75], 4, v[72:73]
    v_mfma_f32_16x16x32_bf16 a[40:43], a[140:143], v[128:131], a[40:43]
    ds_read_b128 a[120:123], v30 offset:0
    v_and_or_b32 v170, v73, s40, v19
    v_mfma_f32_16x16x32_bf16 a[40:43], a[144:147], v[136:139], a[40:43]
    v_perm_b32 v168, v67, v66, v168
    v_and_or_b32 v169, v74, s40, v19
    v_mfma_f32_16x16x32_bf16 a[40:43], a[148:151], v[144:147], a[40:43]
    ds_read_b128 a[124:127], v31 offset:0
    v_perm_b32 v170, v67, v66, v170
    v_mfma_f32_16x16x32_bf16 a[44:47], a[136:139], v[124:127], a[44:47]
    v_and_or_b32 v171, v75, s40, v19
    v_perm_b32 v169, v67, v66, v169
    v_mfma_f32_16x16x32_bf16 a[44:47], a[140:143], v[132:135], a[44:47]
    ds_read_b128 a[128:131], v32 offset:0
    v_perm_b32 v171, v67, v66, v171
    v_mfma_f32_16x16x32_bf16 a[44:47], a[144:147], v[140:143], a[44:47]
    v_perm_b32 v76, v71, v45, s36
    v_perm_b32 v77, v71, v45, s37
    v_mfma_f32_16x16x32_bf16 a[44:47], a[148:151], v[148:151], a[44:47]
    s_waitcnt lgkmcnt(7)
    ds_read_b128 a[132:135], v33 offset:0
    v_and_or_b32 v172, v76, s40, v19
    v_mfma_f32_16x16x32_bf16 a[48:51], a[152:155], v[120:123], a[48:51]
    s_nop 0
    v_lshrrev_b64 v[78:79], 4, v[76:77]
    v_and_or_b32 v174, v77, s40, v19
    v_mfma_f32_16x16x32_bf16 a[48:51], a[156:159], v[128:131], a[48:51]
    ds_read_b128 a[136:139], v30 offset:4096
    v_perm_b32 v172, v69, v68, v172
    v_mfma_f32_16x16x32_bf16 a[48:51], a[160:163], v[136:139], a[48:51]
    v_and_or_b32 v173, v78, s40, v19
    v_perm_b32 v174, v69, v68, v174
    v_mfma_f32_16x16x32_bf16 a[48:51], a[164:167], v[144:147], a[48:51]
    ds_read_b128 a[140:143], v31 offset:4096
    v_and_or_b32 v175, v79, s40, v19
    v_mfma_f32_16x16x32_bf16 a[52:55], a[152:155], v[124:127], a[52:55]
    v_perm_b32 v173, v69, v68, v173
    v_perm_b32 v175, v69, v68, v175
    v_mfma_f32_16x16x32_bf16 a[52:55], a[156:159], v[132:135], a[52:55]
    ds_read_b128 a[144:147], v32 offset:4096
    v_perm_b32 v72, v70, v44, s38
    v_mfma_f32_16x16x32_bf16 a[52:55], a[160:163], v[140:143], a[52:55]
    v_perm_b32 v73, v70, v44, s39
    v_mfma_f32_16x16x32_bf16 a[52:55], a[164:167], v[148:151], a[52:55]
    s_waitcnt lgkmcnt(7)
    ds_read_b128 a[148:151], v33 offset:4096
    v_and_or_b32 v176, v72, s40, v19
    v_mfma_f32_16x16x32_bf16 v[248:251], a[168:171], v[120:123], v[248:251]
    s_barrier
    v_mfma_f32_16x16x32_bf16 v[248:251], a[172:175], v[128:131], v[248:251]
    ds_read_b128 a[152:155], v30 offset:8192
    v_lshrrev_b64 v[74:75], 4, v[72:73]
    v_mfma_f32_16x16x32_bf16 v[248:251], a[176:179], v[136:139], v[248:251]
    v_and_or_b32 v178, v73, s40, v19
    v_perm_b32 v176, v67, v66, v176
    v_mfma_f32_16x16x32_bf16 v[248:251], a[180:183], v[144:147], v[248:251]
    ds_read_b128 a[156:159], v31 offset:8192
    v_and_or_b32 v177, v74, s40, v19
    v_mfma_f32_16x16x32_bf16 v[252:255], a[168:171], v[124:127], v[252:255]
    v_perm_b32 v178, v67, v66, v178
    v_and_or_b32 v179, v75, s40, v19
    v_mfma_f32_16x16x32_bf16 v[252:255], a[172:175], v[132:135], v[252:255]
    ds_read_b128 a[160:163], v32 offset:8192
    v_perm_b32 v177, v67, v66, v177
    v_mfma_f32_16x16x32_bf16 v[252:255], a[176:179], v[140:143], v[252:255]
    v_perm_b32 v179, v67, v66, v179
    v_perm_b32 v76, v71, v45, s38
    v_mfma_f32_16x16x32_bf16 v[252:255], a[180:183], v[148:151], v[252:255]
    s_waitcnt lgkmcnt(7)
    ds_read_b128 a[164:167], v33 offset:8192
    v_perm_b32 v77, v71, v45, s39
    v_mfma_f32_16x16x32_bf16 a[0:3], a[120:123], v[152:155], a[0:3]
    s_nop 0
    v_and_or_b32 v180, v76, s40, v19
    v_lshrrev_b64 v[78:79], 4, v[76:77]
    v_mfma_f32_16x16x32_bf16 a[0:3], a[124:127], v[160:163], a[0:3]
    ds_read_b128 a[168:171], v30 offset:12288
    v_and_or_b32 v182, v77, s40, v19
    v_mfma_f32_16x16x32_bf16 a[0:3], a[128:131], v[168:171], a[0:3]
    v_perm_b32 v180, v69, v68, v180
    v_and_or_b32 v181, v78, s40, v19
    v_mfma_f32_16x16x32_bf16 a[0:3], a[132:135], v[176:179], a[0:3]
    ds_read_b128 a[172:175], v31 offset:12288
    v_perm_b32 v182, v69, v68, v182
    v_mfma_f32_16x16x32_bf16 a[4:7], a[120:123], v[156:159], a[4:7]
    v_and_or_b32 v183, v79, s40, v19
    v_perm_b32 v181, v69, v68, v181
    v_mfma_f32_16x16x32_bf16 a[4:7], a[124:127], v[164:167], a[4:7]
    ds_read_b128 a[176:179], v32 offset:12288
    v_perm_b32 v183, v69, v68, v183
    v_mfma_f32_16x16x32_bf16 a[4:7], a[128:131], v[172:175], a[4:7]
    s_nop 0
    v_mfma_f32_16x16x32_bf16 a[4:7], a[132:135], v[180:183], a[4:7]
    s_waitcnt lgkmcnt(7)
    ds_read_b128 a[180:183], v33 offset:12288
    v_mfma_f32_16x16x32_bf16 a[8:11], a[136:139], v[152:155], a[8:11]
    v_accvgpr_read_b32 v38, a0
    v_accvgpr_read_b32 v39, a1
    v_mfma_f32_16x16x32_bf16 a[8:11], a[140:143], v[160:163], a[8:11]
    ds_read_b128 a[120:123], v30 offset:16384
    v_accvgpr_read_b32 v40, a2
    v_mfma_f32_16x16x32_bf16 a[8:11], a[144:147], v[168:171], a[8:11]
    v_accvgpr_read_b32 v41, a3
    v_mfma_f32_16x16x32_bf16 a[8:11], a[148:151], v[176:179], a[8:11]
    ds_read_b128 a[124:127], v31 offset:16384
    v_accvgpr_read_b32 v42, a4
    v_mfma_f32_16x16x32_bf16 a[12:15], a[136:139], v[156:159], a[12:15]
    v_accvgpr_read_b32 v43, a5
    v_accvgpr_read_b32 v44, a6
    v_mfma_f32_16x16x32_bf16 a[12:15], a[140:143], v[164:167], a[12:15]
    ds_read_b128 a[128:131], v32 offset:16384
    v_accvgpr_read_b32 v45, a7
    v_mfma_f32_16x16x32_bf16 a[12:15], a[144:147], v[172:175], a[12:15]
    v_cvt_pk_bf16_f32 v38, v38, v42
    v_cvt_pk_bf16_f32 v39, v39, v43
    v_mfma_f32_16x16x32_bf16 a[12:15], a[148:151], v[180:183], a[12:15]
    s_waitcnt lgkmcnt(7)
    ds_read_b128 a[132:135], v33 offset:16384
    v_cvt_pk_bf16_f32 v40, v40, v44
    v_mfma_f32_16x16x32_bf16 a[16:19], a[152:155], v[152:155], a[16:19]
    s_nop 0
    v_cvt_pk_bf16_f32 v41, v41, v45
    v_accvgpr_read_b32 v46, a8
    v_mfma_f32_16x16x32_bf16 a[16:19], a[156:159], v[160:163], a[16:19]
    s_add_u32 s8, s47, 0
    ds_read_b128 a[136:139], v30 offset:20480
    v_accvgpr_read_b32 v47, a9
    v_mfma_f32_16x16x32_bf16 a[16:19], a[160:163], v[168:171], a[16:19]
    buffer_store_dword v38, v20, s[32:35], s8 offen sc1
    v_mfma_f32_16x16x32_bf16 a[16:19], a[164:167], v[176:179], a[16:19]
    s_nop 0
    ds_read_b128 a[140:143], v31 offset:20480
    v_accvgpr_read_b32 v48, a10
    v_mfma_f32_16x16x32_bf16 a[20:23], a[152:155], v[156:159], a[20:23]
    buffer_store_dword v39, v21, s[32:35], s8 offen sc1
    v_mfma_f32_16x16x32_bf16 a[20:23], a[156:159], v[164:167], a[20:23]
    ds_read_b128 a[144:147], v32 offset:20480
    v_accvgpr_read_b32 v49, a11
    v_mfma_f32_16x16x32_bf16 a[20:23], a[160:163], v[172:175], a[20:23]
    buffer_store_dword v40, v22, s[32:35], s8 offen sc1
    v_mfma_f32_16x16x32_bf16 a[20:23], a[164:167], v[180:183], a[20:23]
    s_waitcnt lgkmcnt(7)
    ds_read_b128 a[148:151], v33 offset:20480
    v_accvgpr_read_b32 v50, a12
    v_mfma_f32_16x16x32_bf16 a[24:27], a[168:171], v[152:155], a[24:27]
    buffer_store_dword v41, v23, s[32:35], s8 offen sc1
    v_mfma_f32_16x16x32_bf16 a[24:27], a[172:175], v[160:163], a[24:27]
    s_nop 0
    ds_read_b128 a[152:155], v30 offset:24576
    v_accvgpr_read_b32 v51, a13
    v_mfma_f32_16x16x32_bf16 a[24:27], a[176:179], v[168:171], a[24:27]
    v_accvgpr_read_b32 v52, a14
    v_accvgpr_read_b32 v53, a15
    v_mfma_f32_16x16x32_bf16 a[24:27], a[180:183], v[176:179], a[24:27]
    ds_read_b128 a[156:159], v31 offset:24576
    v_cvt_pk_bf16_f32 v46, v46, v50
    v_mfma_f32_16x16x32_bf16 a[28:31], a[168:171], v[156:159], a[28:31]
    v_cvt_pk_bf16_f32 v47, v47, v51
    v_cvt_pk_bf16_f32 v48, v48, v52
    v_mfma_f32_16x16x32_bf16 a[28:31], a[172:175], v[164:167], a[28:31]
    s_add_u32 s9, s47, 114688
    ds_read_b128 a[160:163], v32 offset:24576
    v_cvt_pk_bf16_f32 v49, v49, v53
    v_mfma_f32_16x16x32_bf16 a[28:31], a[176:179], v[172:175], a[28:31]
    buffer_store_dword v46, v20, s[32:35], s9 offen sc1
    v_mfma_f32_16x16x32_bf16 a[28:31], a[180:183], v[180:183], a[28:31]
    s_waitcnt lgkmcnt(7)
    ds_read_b128 a[164:167], v33 offset:24576
    v_accvgpr_read_b32 v54, a16
    v_mfma_f32_16x16x32_bf16 a[32:35], a[120:123], v[152:155], a[32:35]
    buffer_store_dword v47, v21, s[32:35], s9 offen sc1
    v_mfma_f32_16x16x32_bf16 a[32:35], a[124:127], v[160:163], a[32:35]
    s_nop 0
    ds_read_b128 a[168:171], v30 offset:28672
    v_accvgpr_read_b32 v55, a17
    v_mfma_f32_16x16x32_bf16 a[32:35], a[128:131], v[168:171], a[32:35]
    buffer_store_dword v48, v22, s[32:35], s9 offen sc1
    v_mfma_f32_16x16x32_bf16 a[32:35], a[132:135], v[176:179], a[32:35]
    ds_read_b128 a[172:175], v31 offset:28672
    v_accvgpr_read_b32 v56, a18
    v_mfma_f32_16x16x32_bf16 a[36:39], a[120:123], v[156:159], a[36:39]
    buffer_store_dword v49, v23, s[32:35], s9 offen sc1
    v_mfma_f32_16x16x32_bf16 a[36:39], a[124:127], v[164:167], a[36:39]
    ds_read_b128 a[176:179], v32 offset:28672
    v_accvgpr_read_b32 v57, a19
    v_mfma_f32_16x16x32_bf16 a[36:39], a[128:131], v[172:175], a[36:39]
    v_accvgpr_read_b32 v58, a20
    v_accvgpr_read_b32 v59, a21
    v_mfma_f32_16x16x32_bf16 a[36:39], a[132:135], v[180:183], a[36:39]
    s_waitcnt lgkmcnt(7)
    ds_read_b128 a[180:183], v33 offset:28672
    v_accvgpr_read_b32 v60, a22
    v_mfma_f32_16x16x32_bf16 a[40:43], a[136:139], v[152:155], a[40:43]
    s_nop 0
    v_accvgpr_read_b32 v61, a23
    v_cvt_pk_bf16_f32 v54, v54, v58
    v_mfma_f32_16x16x32_bf16 a[40:43], a[140:143], v[160:163], a[40:43]
    v_cvt_pk_bf16_f32 v55, v55, v59
    v_cvt_pk_bf16_f32 v56, v56, v60
    v_mfma_f32_16x16x32_bf16 a[40:43], a[144:147], v[168:171], a[40:43]
    v_cvt_pk_bf16_f32 v57, v57, v61
    v_accvgpr_read_b32 v62, a24
    v_mfma_f32_16x16x32_bf16 a[40:43], a[148:151], v[176:179], a[40:43]
    s_add_u32 s10, s47, 229376
    v_accvgpr_read_b32 v63, a25
    v_accvgpr_read_b32 v64, a26
    v_mfma_f32_16x16x32_bf16 a[44:47], a[136:139], v[156:159], a[44:47]
    buffer_store_dword v54, v20, s[32:35], s10 offen sc1
    v_mfma_f32_16x16x32_bf16 a[44:47], a[140:143], v[164:167], a[44:47]
    v_accvgpr_read_b32 v65, a27
    v_accvgpr_read_b32 v66, a28
    v_mfma_f32_16x16x32_bf16 a[44:47], a[144:147], v[172:175], a[44:47]
    buffer_store_dword v55, v21, s[32:35], s10 offen sc1
    v_mfma_f32_16x16x32_bf16 a[44:47], a[148:151], v[180:183], a[44:47]
    s_waitcnt lgkmcnt(4)
    v_accvgpr_read_b32 v67, a29
    v_accvgpr_read_b32 v68, a30
    v_mfma_f32_16x16x32_bf16 a[48:51], a[152:155], v[152:155], a[48:51]
    buffer_store_dword v56, v22, s[32:35], s10 offen sc1
    v_mfma_f32_16x16x32_bf16 a[48:51], a[156:159], v[160:163], a[48:51]
    s_nop 0
    v_accvgpr_read_b32 v69, a31
    v_cvt_pk_bf16_f32 v62, v62, v66
    v_mfma_f32_16x16x32_bf16 a[48:51], a[160:163], v[168:171], a[48:51]
    buffer_store_dword v57, v23, s[32:35], s10 offen sc1
    v_mfma_f32_16x16x32_bf16 a[48:51], a[164:167], v[176:179], a[48:51]
    v_cvt_pk_bf16_f32 v63, v63, v67
    v_cvt_pk_bf16_f32 v64, v64, v68
    v_mfma_f32_16x16x32_bf16 a[52:55], a[152:155], v[156:159], a[52:55]
    v_cvt_pk_bf16_f32 v65, v65, v69
    v_accvgpr_read_b32 v38, a32
    v_mfma_f32_16x16x32_bf16 a[52:55], a[156:159], v[164:167], a[52:55]
    s_add_u32 s11, s47, 344064
    v_accvgpr_read_b32 v39, a33
    v_accvgpr_read_b32 v40, a34
    v_mfma_f32_16x16x32_bf16 a[52:55], a[160:163], v[172:175], a[52:55]
    buffer_store_dword v62, v20, s[32:35], s11 offen sc1
    v_mfma_f32_16x16x32_bf16 a[52:55], a[164:167], v[180:183], a[52:55]
    s_waitcnt lgkmcnt(0)
    v_accvgpr_read_b32 v41, a35
    v_accvgpr_read_b32 v42, a36
    v_mfma_f32_16x16x32_bf16 v[248:251], a[168:171], v[152:155], v[248:251]
    buffer_store_dword v63, v21, s[32:35], s11 offen sc1
    v_mfma_f32_16x16x32_bf16 v[248:251], a[172:175], v[160:163], v[248:251]
    s_nop 0
    v_accvgpr_read_b32 v43, a37
    v_accvgpr_read_b32 v44, a38
    v_mfma_f32_16x16x32_bf16 v[248:251], a[176:179], v[168:171], v[248:251]
    buffer_store_dword v64, v22, s[32:35], s11 offen sc1
    v_mfma_f32_16x16x32_bf16 v[248:251], a[180:183], v[176:179], v[248:251]
    v_accvgpr_read_b32 v45, a39
    v_cvt_pk_bf16_f32 v38, v38, v42
    v_mfma_f32_16x16x32_bf16 v[252:255], a[168:171], v[156:159], v[252:255]
    buffer_store_dword v65, v23, s[32:35], s11 offen sc1
    v_mfma_f32_16x16x32_bf16 v[252:255], a[172:175], v[164:167], v[252:255]
    v_cvt_pk_bf16_f32 v39, v39, v43
    v_cvt_pk_bf16_f32 v40, v40, v44
    v_mfma_f32_16x16x32_bf16 v[252:255], a[176:179], v[172:175], v[252:255]
    v_cvt_pk_bf16_f32 v41, v41, v45
    v_mfma_f32_16x16x32_bf16 v[252:255], a[180:183], v[180:183], v[252:255]
    s_add_u32 s8, s47, 458752
    buffer_store_dword v38, v20, s[32:35], s8 offen sc1
    buffer_store_dword v39, v21, s[32:35], s8 offen sc1
    buffer_store_dword v40, v22, s[32:35], s8 offen sc1
    buffer_store_dword v41, v23, s[32:35], s8 offen sc1
    v_accvgpr_read_b32 v46, a40
    v_accvgpr_read_b32 v47, a41
    v_accvgpr_read_b32 v48, a42
    v_accvgpr_read_b32 v49, a43
    v_accvgpr_read_b32 v50, a44
    v_accvgpr_read_b32 v51, a45
    v_accvgpr_read_b32 v52, a46
    v_accvgpr_read_b32 v53, a47
    v_cvt_pk_bf16_f32 v46, v46, v50
    v_cvt_pk_bf16_f32 v47, v47, v51
    v_cvt_pk_bf16_f32 v48, v48, v52
    v_cvt_pk_bf16_f32 v49, v49, v53
    s_add_u32 s9, s47, 573440
    buffer_store_dword v46, v20, s[32:35], s9 offen sc1
    buffer_store_dword v47, v21, s[32:35], s9 offen sc1
    buffer_store_dword v48, v22, s[32:35], s9 offen sc1
    buffer_store_dword v49, v23, s[32:35], s9 offen sc1
    v_accvgpr_read_b32 v54, a48
    v_accvgpr_read_b32 v55, a49
    v_accvgpr_read_b32 v56, a50
    v_accvgpr_read_b32 v57, a51
    v_accvgpr_read_b32 v58, a52
    v_accvgpr_read_b32 v59, a53
    v_accvgpr_read_b32 v60, a54
    v_accvgpr_read_b32 v61, a55
    v_cvt_pk_bf16_f32 v54, v54, v58
    v_cvt_pk_bf16_f32 v55, v55, v59
    v_cvt_pk_bf16_f32 v56, v56, v60
    v_cvt_pk_bf16_f32 v57, v57, v61
    s_add_u32 s10, s47, 688128
    buffer_store_dword v54, v20, s[32:35], s10 offen sc1
    buffer_store_dword v55, v21, s[32:35], s10 offen sc1
    buffer_store_dword v56, v22, s[32:35], s10 offen sc1
    buffer_store_dword v57, v23, s[32:35], s10 offen sc1
    v_cvt_pk_bf16_f32 v62, v248, v252
    v_cvt_pk_bf16_f32 v63, v249, v253
    v_cvt_pk_bf16_f32 v64, v250, v254
    v_cvt_pk_bf16_f32 v65, v251, v255
    s_add_u32 s11, s47, 802816
    buffer_store_dword v62, v20, s[32:35], s11 offen sc1
    buffer_store_dword v63, v21, s[32:35], s11 offen sc1
    buffer_store_dword v64, v22, s[32:35], s11 offen sc1
    buffer_store_dword v65, v23, s[32:35], s11 offen sc1
    s_endpgm
L_exit:
    s_endpgm
.p2align 12
L_end:
.section .rodata,"a"
.p2align 6
.amdhsa_kernel standalone__weight_only_int_gptq__prompt_kernel
  .amdhsa_next_free_vgpr 440
  .amdhsa_next_free_sgpr 96
  .amdhsa_accum_offset 256
  .amdhsa_group_segment_fixed_size 0
  .amdhsa_kernarg_size 64
  .amdhsa_user_sgpr_count 2
  .amdhsa_user_sgpr_kernarg_segment_ptr 1
  .amdhsa_system_sgpr_workgroup_id_x 1
  .amdhsa_float_denorm_mode_32 3
.end_amdhsa_kernel
```
